```python
import torch

def _softmax(x, axis=-1):
    return torch.softmax(x, dim=axis)
def _gelu(x):
    return torch.nn.functional.gelu(x, approximate="tanh")
def _silu(x):
    return torch.nn.functional.silu(x)
def _sigmoid(x):
    return torch.sigmoid(x)
def _layernorm(x, axis=-1, eps=1e-5):
    m = x.mean(dim=axis, keepdim=True)
    v = x.var(dim=axis, keepdim=True, unbiased=False)
    return (x - m) / torch.sqrt(v + eps)
def _scatter_add(tgt, idx, src, axis=0):
    return tgt.clone().index_add_(axis, idx, src)
def _segment_sum(src, seg, n):
    out = torch.zeros((n,) + src.shape[1:], dtype=src.dtype)
    return out.index_add_(0, seg, src)
def _pad(x, pw):
    flat = tuple(v for pair in reversed(pw) for v in pair)
    return torch.nn.functional.pad(x, flat)

kernel_name = 'parallel_sum__spectral_gfnet__dense_activation_silu__prompt'

def setup_inputs():

    _w = (lambda a: (lambda t: t.to(torch.bfloat16) if t.is_floating_point() else t)(torch.as_tensor(a)))
    def _A_setup():
        B, S, D = 1, 2048, 512
        Df = D // 2 + 1
        return {
            "x": _w((lambda *s: torch.randn(*s, dtype=torch.bfloat16) * 0.05)(B, S, D)),
            "w_r": _w((lambda *s: torch.randn(*s, dtype=torch.bfloat16) * 0.8)(S, Df) * 0.02),
            "w_i": _w((lambda *s: torch.randn(*s, dtype=torch.bfloat16) * 0.8)(S, Df) * 0.02),
        }
    _A_in = _A_setup()

    def _B_setup():
        B, S, D, F = 1, 2048, 512, 1376
        return {
            "x": _w((lambda *s: torch.randn(*s, dtype=torch.bfloat16) * 0.05)(B, S, D)),
            "w1": _w((lambda *s: torch.randn(*s, dtype=torch.bfloat16) * 0.8)(D, F) * (D ** -0.5)),
            "w2": _w((lambda *s: torch.randn(*s, dtype=torch.bfloat16) * 0.1)(F, D) * (F ** -0.5)),
        }
    _B_in = _B_setup()

    return {
        "A_x": _A_in["x"],
        "A_w_r": _A_in["w_r"],
        "A_w_i": _A_in["w_i"],
        "B_x": _B_in["x"],
        "B_w1": _B_in["w1"],
        "B_w2": _B_in["w2"],
    }

def reference(A_x, A_w_r, A_w_i, B_x, B_w1, B_w2):
    def _A_ref(x, w_r, w_i):
        B, S, D = x.shape
        X = (lambda x, axes=(-2,-1): torch.fft.rfft2(x.float(), dim=axes))(x, axes=(-2, -1))
        W = w_r + 1j * w_i
        X = X * W
        y = (lambda x, s, axes=(-2,-1): torch.fft.irfft2(x, s=s, dim=axes).to(torch.bfloat16))(X, (S, D), axes=(-2, -1))
        return y

    def _B_ref(x, w1, w2):
        h = torch.einsum("bsd,df->bsf", x, w1)
        h = _silu(h)
        out = torch.einsum("bsf,fd->bsd", h, w2)
        return out

    x = A_x
    xn = _layernorm(x, axis=-1)
    return x + _A_ref(xn, A_w_r, A_w_i) + _B_ref(xn, B_w1, B_w2)
```

```asm
; @launch grid=(256,1,1) block=(512,1,1) lds=163840
.amdgcn_target "amdgcn-amd-amdhsa--gfx950"
.text
.globl parallel_sum__spectral_gfnet__dense_activation_silu__prompt_kernel
.p2align 8
.type parallel_sum__spectral_gfnet__dense_activation_silu__prompt_kernel,@function
parallel_sum__spectral_gfnet__dense_activation_silu__prompt_kernel:
    s_cmp_ge_u32 s2, 256
    s_cbranch_scc1 L_x
    s_load_dwordx2 s[8:9], s[0:1], 0
    s_load_dwordx2 s[12:13], s[0:1], 32
    s_load_dwordx2 s[20:21], s[0:1], 64
    s_load_dwordx2 s[16:17], s[0:1], 40
    s_load_dwordx2 s[28:29], s[0:1], 8
    s_load_dwordx2 s[32:33], s[0:1], 16
    s_load_dwordx2 s[24:25], s[0:1], 48
    s_load_dwordx2 s[36:37], s[0:1], 56
    v_lshrrev_b32 v1, 6, v0
    v_and_b32 v2, 63, v0
    v_readfirstlane_b32 s3, v1
    v_lshlrev_b32 v244, 7, v2
    s_lshr_b32 s5, s2, 3
    s_and_b32 s52, s5, 7
    s_cmp_lg_u32 s52, s3
    s_nop 0
    s_cbranch_scc1 L_nocpf
    s_getpc_b64 s[52:53]
L_pc:
    s_sub_u32 s52, s52, L_pc-parallel_sum__spectral_gfnet__dense_activation_silu__prompt_kernel
    s_subb_u32 s53, s53, 0
    s_lshl_b32 s54, s3, 13
    v_add_u32 v10, s54, v244
    v_min_u32 v10, L_codeend-parallel_sum__spectral_gfnet__dense_activation_silu__prompt_kernel-4, v10
    global_load_dword v255, v10, s[52:53]
    s_nop 0
L_nocpf:
    v_and_b32 v3, 15, v2
    v_lshrrev_b32 v4, 4, v2
    v_lshlrev_b32 v5, 4, v2
    s_and_b32 s4, s2, 7
    s_and_b32 s6, s3, 3
    s_lshr_b32 s7, s3, 2
    s_mov_b32 s10, 0x00200000
    s_mov_b32 s11, 0x00020000
    s_mov_b32 s14, 0x00158000
    s_mov_b32 s15, 0x00020000
    s_mov_b32 s22, 0x00e00000
    s_mov_b32 s23, 0x00020000
    s_mov_b32 s18, 0x00158000
    s_mov_b32 s19, 0x00020000
    s_mov_b32 s30, 0x00101000
    s_mov_b32 s31, 0x00020000
    s_mov_b32 s34, 0x00101000
    s_mov_b32 s35, 0x00020000
    s_mov_b32 s26, 0x00200000
    s_mov_b32 s27, 0x00020000
    s_mov_b32 s38, 0x00000100
    s_mov_b32 s39, 0x00020000
    s_lshl_b32 s43, s4, 1
    s_and_b32 s52, s5, 1
    s_add_u32 s43, s43, s52
    s_lshr_b32 s44, s5, 1
    s_and_b32 s50, s4, 2
    s_lshl_b32 s50, s50, 1
    s_lshl_b32 s45, s43, 2
    s_add_u32 s45, s45, s6
    v_lshrrev_b32 v10, 3, v2
    v_lshlrev_b32 v10, 16, v10
    v_and_b32 v11, 7, v2
    v_xor_b32 v11, v11, v4
    s_and_b32 s52, s3, 1
    s_lshl_b32 s52, s52, 20
    s_lshl_b32 s53, s43, 2
    s_lshr_b32 s54, s3, 1
    s_add_u32 s53, s53, s54
    s_lshl_b32 s53, s53, 10
    s_add_u32 s52, s52, s53
    v_add_u32 v10, s52, v10
    v_lshl_add_u32 v6, v11, 4, v10
    v_xor_b32 v11, 4, v11
    v_lshl_add_u32 v7, v11, 4, v10
    v_add_u32 v7, 0x80000, v7
    s_lshl_b32 s46, s3, 11
    s_cmp_ge_u32 s44, 11
    s_cselect_b32 s52, 32768, 0
    s_add_u32 s53, s46, s52
    s_lshl_b32 s52, s50, 7
    s_mov_b32 m0, s53
    s_waitcnt lgkmcnt(0)
    s_and_b32 s9, s9, 0xffff
    buffer_load_dwordx4 v6, s[8:11], s52 offen lds
    s_add_u32 m0, s53, 1024
    s_nop 0
    buffer_load_dwordx4 v7, s[8:11], s52 offen lds
    s_and_b32 s13, s13, 0xffff
    s_cmp_ge_u32 s44, 11
    s_cbranch_scc1 L_g1_S
    s_lshl_b32 s52, s3, 3
    v_add_u32 v11, s52, v4
    s_mov_b32 s52, 2752
    v_mul_lo_u32 v11, v11, s52
    s_lshl_b32 s52, s44, 8
    v_add_u32 v11, s52, v11
    s_and_b32 s52, s3, 1
    s_lshl_b32 s52, s52, 3
    v_lshlrev_b32 v10, 1, v4
    v_xor_b32 v10, v10, v3
    v_xor_b32 v10, s52, v10
    v_lshl_add_u32 v8, v10, 4, v11
    s_lshl_b32 s52, s50, 7
    s_mul_i32 s53, s50, 176128
    s_add_u32 m0, s46, 16384
    s_nop 0
    buffer_load_dwordx4 v8, s[12:15], s53 offen lds
    s_add_u32 m0, s46, 17408
    s_add_u32 s53, s53, 11008
    buffer_load_dwordx4 v8, s[12:15], s53 offen lds
    s_add_u32 s50, s50, 1
    s_and_b32 s50, s50, 7
    s_and_b32 s21, s21, 0xffff
    s_and_b32 s17, s17, 0xffff
    s_and_b32 s29, s29, 0xffff
    s_and_b32 s33, s33, 0xffff
    s_and_b32 s25, s25, 0xffff
    s_and_b32 s37, s37, 0xffff
    v_lshrrev_b32 v10, 2, v3
    v_lshl_add_u32 v11, v4, 3, v10
    v_lshlrev_b32 v11, 8, v11
    v_and_b32 v12, 1, v4
    v_lshl_add_u32 v10, v12, 2, v10
    s_lshl_b32 s52, s7, 2
    s_add_u32 s52, s52, s6
    v_xor_b32 v10, s52, v10
    v_lshl_add_u32 v11, v10, 5, v11
    v_and_b32 v12, 3, v2
    v_lshl_add_u32 v11, v12, 3, v11
    v_add_u32 v11, 16384, v11
    v_xor_b32 v192, 0, v11
    v_add_u32 v196, 0x10000, v192
    v_xor_b32 v193, 32, v11
    v_add_u32 v197, 0x10000, v193
    v_xor_b32 v194, 64, v11
    v_add_u32 v198, 0x10000, v194
    v_xor_b32 v195, 96, v11
    v_add_u32 v199, 0x10000, v195
    v_lshrrev_b32 v10, 1, v3
    v_xor_b32 v10, v10, v4
    s_lshl_b32 s52, s6, 12
    s_lshl_b32 s53, s7, 11
    s_add_u32 s52, s52, s53
    v_lshlrev_b32 v11, 7, v3
    v_lshl_add_u32 v11, v10, 4, v11
    v_add_u32 v116, s52, v11
    v_xor_b32 v117, 2048, v116
    v_xor_b32 v118, 64, v116
    v_xor_b32 v119, 64, v117
    v_add_u32 v120, 0x10000, v116
    v_add_u32 v121, 0x10000, v117
    v_add_u32 v122, 0x10000, v118
    v_add_u32 v123, 0x10000, v119
    v_cmp_eq_u32 s[56:57], 0, v3
    v_and_b32 v10, 3, v3
    v_cmp_eq_u32 s[58:59], 1, v10
    v_cmp_eq_u32 s[60:61], 2, v10
    v_cmp_eq_u32 s[62:63], 3, v10
    v_lshrrev_b32 v10, 2, v3
    v_cmp_eq_u32 s[64:65], v10, v4
    v_mov_b32 v56, 0x3f803f80
    v_mov_b32 v57, 0x3f803f80
    v_mov_b32 v58, 0x3f803f80
    v_mov_b32 v59, 0x3f803f80
    s_lshl_b32 s52, s50, 7
    s_mul_i32 s53, s50, 176128
    s_add_u32 m0, s46, 32768
    s_nop 0
    buffer_load_dwordx4 v6, s[8:11], s52 offen lds
    s_add_u32 m0, s46, 33792
    s_nop 0
    buffer_load_dwordx4 v7, s[8:11], s52 offen lds
    s_add_u32 m0, s46, 49152
    s_nop 0
    buffer_load_dwordx4 v8, s[12:15], s53 offen lds
    s_add_u32 m0, s46, 50176
    s_add_u32 s53, s53, 11008
    buffer_load_dwordx4 v8, s[12:15], s53 offen lds
    s_add_u32 s50, s50, 1
    s_and_b32 s50, s50, 7
    v_mov_b32 v9, 0
    s_cmp_lg_u32 s2, 0
    s_nop 0
    s_cbranch_scc1 L_noinit
    v_lshlrev_b32 v10, 8, v0
    s_mov_b32 s52, 12582912
    buffer_store_dword v9, v10, s[20:23], s52 offen sc1
    s_nop 1
L_noinit:
    s_lshl_b32 s68, s4, 2
    s_and_b32 s52, s5, 3
    s_add_u32 s68, s68, s52
    s_lshr_b32 s69, s5, 2
    s_lshl_b32 s70, s68, 1
    s_lshr_b32 s52, s6, 1
    s_add_u32 s70, s70, s52
    s_and_b32 s71, s6, 1
    s_mul_i32 s72, s70, 88
    s_lshl_b32 s52, s7, 1
    s_add_u32 s72, s72, s52
    s_add_u32 s72, s72, s71
    s_lshl_b32 s72, s72, 10
    s_lshl_b32 s73, s3, 11
    s_cmp_ge_u32 s3, 6
    s_cselect_b32 s77, 1277952, -1
    s_mul_i32 s74, s68, 69632
    s_add_u32 s74, s74, 9437184
    s_and_b32 s52, s5, 3
    s_mul_i32 s52, s52, 3
    s_add_u32 s75, s69, s4
    s_add_u32 s75, s75, s52
    s_cmp_ge_u32 s75, 11
    s_cselect_b32 s52, 11, 0
    s_sub_u32 s75, s75, s52
    s_cmp_ge_u32 s75, 11
    s_cselect_b32 s52, 11, 0
    s_sub_u32 s75, s75, s52
    v_lshrrev_b32 v10, 3, v2
    v_and_b32 v11, 7, v2
    v_and_b32 v12, 6, v10
    v_xor_b32 v11, v11, v12
    s_lshl_b32 s52, s3, 14
    s_lshl_b32 s53, s69, 7
    s_add_u32 s52, s52, s53
    v_lshlrev_b32 v10, 10, v10
    v_lshl_add_u32 v10, v11, 4, v10
    v_add_u32 v247, s52, v10
    s_lshl_b32 s52, s71, 20
    s_lshl_b32 s53, s70, 10
    s_add_u32 s52, s52, s53
    s_lshl_b32 s53, s69, 7
    s_add_u32 s52, s52, s53
    s_lshl_b32 s53, s7, 6
    s_add_u32 s52, s52, s53
    v_lshlrev_b32 v253, 16, v3
    v_lshl_add_u32 v253, v4, 3, v253
    v_add_u32 v253, s52, v253
    v_and_b32 v10, 1, v4
    v_mul_u32_u24 v10, 24, v10
    v_add_u32 v253, v10, v253
    v_lshrrev_b32 v10, 2, v3
    v_lshl_add_u32 v10, v4, 2, v10
    v_and_b32 v11, 6, v10
    v_and_b32 v12, 3, v2
    v_lshrrev_b32 v13, 1, v12
    v_xor_b32 v11, v11, v13
    v_and_b32 v12, 1, v12
    v_lshlrev_b32 v10, 7, v10
    v_lshl_add_u32 v10, v12, 3, v10
    s_lshl_b32 s52, s7, 13
    s_lshl_b32 s53, s71, 12
    s_add_u32 s52, s52, s53
    v_add_u32 v10, s52, v10
    s_mul_i32 s52, s71, 45056
    s_sub_u32 s53, 45056, s52
    v_add_u32 v248, s52, v5
    v_add_u32 v249, s53, v5
    s_lshl_b32 s52, s7, 2
    v_xor_b32 v11, s52, v11
    v_xor_b32 v12, 0, v11
    v_lshl_add_u32 v224, v12, 4, v10
    v_add_u32 v228, 0x10000, v224
    v_add_u32 v240, 0x20000, v224
    v_xor_b32 v12, 2, v11
    v_lshl_add_u32 v225, v12, 4, v10
    v_add_u32 v229, 0x10000, v225
    v_add_u32 v241, 0x20000, v225
    v_xor_b32 v12, 4, v11
    v_lshl_add_u32 v226, v12, 4, v10
    v_add_u32 v230, 0x10000, v226
    v_add_u32 v242, 0x20000, v226
    v_xor_b32 v12, 6, v11
    v_lshl_add_u32 v227, v12, 4, v10
    v_add_u32 v231, 0x10000, v227
    v_add_u32 v243, 0x20000, v227
    v_lshrrev_b32 v10, 3, v3
    v_and_b32 v11, 1, v4
    v_lshl_add_u32 v10, v10, 1, v11
    s_lshl_b32 s52, s71, 1
    v_xor_b32 v10, s52, v10
    v_lshlrev_b32 v10, 4, v10
    v_lshl_add_u32 v10, v3, 6, v10
    s_lshr_b32 s52, s6, 1
    s_lshl_b32 s52, s52, 11
    s_add_u32 s53, s52, 151552
    s_add_u32 s52, s52, 114688
    v_add_u32 v237, s53, v10
    v_lshrrev_b32 v11, 1, v4
    v_lshl_add_u32 v10, v11, 12, v10
    v_add_u32 v236, s52, v10
    v_subrev_u32 v238, 98304, v236
    s_cmp_ge_u32 s3, 6
    s_nop 0
    s_cbranch_scc1 L_noftF
    s_and_b32 s52, s3, 1
    s_lshl_b32 s52, s52, 4
    v_add_u32 v10, s52, v3
    s_lshr_b32 s52, s3, 1
    s_cmp_ge_u32 s52, 2
    s_cselect_b32 s53, 0, 1
    s_cselect_b32 s54, 3, 2
    s_cselect_b32 s55, 1, 0
    s_cmp_eq_u32 s52, 1
    s_cselect_b32 s52, 1, 0
    v_lshlrev_b32 v10, s53, v10
    v_add_u32 v10, s52, v10
    v_lshlrev_b32 v11, s54, v4
    v_add_u32 v11, s55, v11
    v_mul_u32_u24 v11, v10, v11
    v_and_b32 v11, 63, v11
    v_lshlrev_b32 v10, s55, v10
    v_cvt_f32_u32 v11, v11
    v_cvt_f32_u32 v10, v10
    v_mul_f32 v11, 0x3c800000, v11
    v_mul_f32 v10, 0x3c800000, v10
    v_cos_f32 v16, v11
    v_sin_f32 v24, v11
    v_fmamk_f32 v12, v10, 0x3f800000, v11
    v_fract_f32 v12, v12
    v_cos_f32 v17, v12
    v_sin_f32 v25, v12
    v_fmamk_f32 v12, v10, 0x40000000, v11
    v_fract_f32 v12, v12
    v_cos_f32 v18, v12
    v_sin_f32 v26, v12
    v_fmamk_f32 v12, v10, 0x40400000, v11
    v_fract_f32 v12, v12
    v_cos_f32 v19, v12
    v_sin_f32 v27, v12
    v_fmamk_f32 v12, v10, 0x41800000, v11
    v_fract_f32 v12, v12
    v_cos_f32 v20, v12
    v_sin_f32 v28, v12
    v_fmamk_f32 v12, v10, 0x41880000, v11
    v_fract_f32 v12, v12
    v_cos_f32 v21, v12
    v_sin_f32 v29, v12
    v_fmamk_f32 v12, v10, 0x41900000, v11
    v_fract_f32 v12, v12
    v_cos_f32 v22, v12
    v_sin_f32 v30, v12
    v_fmamk_f32 v12, v10, 0x41980000, v11
    v_fract_f32 v12, v12
    v_cos_f32 v23, v12
    v_sin_f32 v31, v12
    v_cvt_pk_bf16_f32 v184, v16, v17
    v_cvt_pk_bf16_f32 v188, v24, v25
    v_cvt_pk_bf16_f32 v185, v18, v19
    v_cvt_pk_bf16_f32 v189, v26, v27
    v_cvt_pk_bf16_f32 v186, v20, v21
    v_cvt_pk_bf16_f32 v190, v28, v29
    v_cvt_pk_bf16_f32 v187, v22, v23
    v_cvt_pk_bf16_f32 v191, v30, v31
    v_lshlrev_b32 v10, 4, v0
    v_add_u32 v10, 151552, v10
    ds_write_b128 v10, v[184:187]
    ds_write_b128 v10, v[188:191] offset:6144
L_noftF:
    s_lshl_b32 s54, s5, 1
    s_add_u32 s54, s54, 32
    s_lshl_b32 s52, s5, 4
    s_sub_u32 s52, s52, 241
    s_cmp_lt_u32 s5, 16
    s_cselect_b32 s54, s54, s52
    s_cselect_b32 s42, 2, 1
    s_add_u32 s52, s5, 46
    s_cmp_lt_u32 s5, 18
    s_cselect_b32 s54, s54, s52
    s_sub_u32 s48, s3, 1
    s_and_b32 s48, s48, 7
    s_lshl_b32 s49, s48, 12
    s_lshr_b32 s52, s54, 4
    s_and_b32 s55, s54, 15
    s_cmp_ge_u32 s54, 64
    s_cselect_b32 s52, s55, s52
    s_cselect_b32 s55, 16, s55
    s_lshl_b32 s100, s4, 1
    s_lshr_b32 s53, s52, 1
    s_add_u32 s100, s100, s53
    s_sub_u32 s53, 32, s100
    s_cmp_eq_u32 s100, 0
    s_cselect_b32 s53, 16, s53
    s_bitcmp1_b32 s52, 0
    s_cselect_b32 s100, s53, s100
    s_add_u32 s47, s55, s48
    s_and_b32 s53, s100, 1
    s_lshl_b32 s53, s53, 1
    s_lshl_b32 s1, s48, 4
    s_add_u32 s1, s1, s53
    s_lshl_b32 s101, s42, 5
    s_add_u32 s101, s101, 32
    s_sub_u32 s101, s101, s1
    s_cmp_lt_u32 s48, s42
    s_cselect_b32 s48, 1, 0
    s_lshl_b32 s51, s47, 5
    s_add_u32 s51, s51, s100
    s_lshl_b32 s55, s55, 4
    s_sub_u32 s54, s55, s53
    s_lshl_b32 s52, s42, 5
    s_add_u32 s55, s55, s52
    s_sub_u32 s55, s53, s55
    s_add_u32 s55, s55, 1053168
    s_lshl_b32 s52, s6, 1
    v_and_b32 v10, 7, v2
    v_xor_b32 v10, s52, v10
    s_lshl_b32 s52, s6, 3
    v_lshrrev_b32 v11, 3, v2
    v_add_u32 v11, s52, v11
    v_lshl_add_u32 v11, v11, 5, s100
    v_mul_u32_u24 v11, 514, v11
    v_sub_u32 v12, s55, v11
    v_add_u32 v11, s54, v11
    v_cmp_lt_u32 vcc, s42, v10
    s_nop 1
    v_cndmask_b32 v11, v11, v12, vcc
    v_cndmask_b32 v185, 1, -1, vcc
    v_lshl_add_u32 v184, v10, 4, v11
    v_subrev_u32 v12, 1052672, v184
    v_min_u32 v186, v12, v184
    s_cmp_ge_u32 s3, 4
    s_cselect_b32 s28, s32, s28
    s_cselect_b32 s29, s33, s29
    s_lshl_b32 s52, s50, 7
    s_mul_i32 s53, s50, 176128
    s_add_u32 m0, s46, 65536
    s_nop 0
    buffer_load_dwordx4 v6, s[8:11], s52 offen lds
    s_add_u32 m0, s46, 66560
    s_nop 0
    buffer_load_dwordx4 v7, s[8:11], s52 offen lds
    s_add_u32 m0, s46, 81920
    s_nop 0
    buffer_load_dwordx4 v8, s[12:15], s53 offen lds
    s_add_u32 m0, s46, 82944
    s_add_u32 s53, s53, 11008
    buffer_load_dwordx4 v8, s[12:15], s53 offen lds
    s_add_u32 s50, s50, 1
    s_and_b32 s50, s50, 7
    s_waitcnt vmcnt(8)
    s_waitcnt lgkmcnt(0)
    s_barrier
    ds_read_b128 v[64:67], v116 offset:0
    ds_read_b128 v[68:71], v117 offset:0
    ds_read_b64_tr_b16 v[80:81], v192 offset:0
    ds_read_b64_tr_b16 v[82:83], v192 offset:1024
    ds_read_b64_tr_b16 v[84:85], v193 offset:0
    ds_read_b64_tr_b16 v[86:87], v193 offset:1024
    ds_read_b64_tr_b16 v[88:89], v194 offset:0
    ds_read_b64_tr_b16 v[90:91], v194 offset:1024
    ds_read_b64_tr_b16 v[92:93], v195 offset:0
    ds_read_b64_tr_b16 v[94:95], v195 offset:1024
    s_waitcnt lgkmcnt(0)
    v_mfma_f32_16x16x32_bf16 v[128:131], v[80:83], v[64:67], 0
    ds_read_b128 v[72:75], v118 offset:0
    v_mfma_f32_16x16x32_bf16 v[132:135], v[80:83], v[68:71], 0
    s_lshl_b32 s66, s50, 7
    s_mul_i32 s67, s50, 176128
    s_add_u32 s50, s50, 1
    s_and_b32 s50, s50, 7
    s_add_u32 m0, s46, 98304
    s_nop 0
    buffer_load_dwordx4 v6, s[8:11], s66 offen lds
    ds_read_b128 v[76:79], v119 offset:0
    v_mfma_f32_16x16x32_bf16 v[136:139], v[84:87], v[64:67], 0
    ds_read_b64_tr_b16 v[96:97], v192 offset:8192
    v_mfma_f32_16x16x32_bf16 v[140:143], v[84:87], v[68:71], 0
    s_add_u32 m0, s46, 99328
    s_nop 0
    buffer_load_dwordx4 v7, s[8:11], s66 offen lds
    ds_read_b64_tr_b16 v[98:99], v192 offset:9216
    v_mfma_f32_16x16x32_bf16 v[144:147], v[88:91], v[64:67], 0
    ds_read_b64_tr_b16 v[100:101], v193 offset:8192
    v_mfma_f32_16x16x32_bf16 v[148:151], v[88:91], v[68:71], 0
    ds_read_b64_tr_b16 v[102:103], v193 offset:9216
    v_mfma_f32_16x16x32_bf16 v[152:155], v[92:95], v[64:67], 0
    s_add_u32 m0, s46, 114688
    s_nop 0
    buffer_load_dwordx4 v8, s[12:15], s67 offen lds
    ds_read_b64_tr_b16 v[104:105], v194 offset:8192
    v_mfma_f32_16x16x32_bf16 v[156:159], v[92:95], v[68:71], 0
    ds_read_b64_tr_b16 v[106:107], v194 offset:9216
    v_mfma_f32_16x16x32_bf16 v[40:43], v[56:59], v[64:67], 0
    ds_read_b64_tr_b16 v[108:109], v195 offset:8192
    v_mfma_f32_16x16x32_bf16 v[44:47], v[64:67], v[64:67], 0
    s_add_u32 m0, s46, 115712
    s_add_u32 s67, s67, 11008
    buffer_load_dwordx4 v8, s[12:15], s67 offen lds
    ds_read_b64_tr_b16 v[110:111], v195 offset:9216
    v_mfma_f32_16x16x32_bf16 v[112:115], v[80:83], v[56:59], 0
    s_waitcnt lgkmcnt(0)
    s_waitcnt vmcnt(8)
    s_barrier
    v_mfma_f32_16x16x32_bf16 v[128:131], v[96:99], v[72:75], v[128:131]
    ds_read_b128 v[64:67], v116 offset:32768
    v_mfma_f32_16x16x32_bf16 v[132:135], v[96:99], v[76:79], v[132:135]
    ds_read_b128 v[68:71], v117 offset:32768
    v_mfma_f32_16x16x32_bf16 v[136:139], v[100:103], v[72:75], v[136:139]
    ds_read_b64_tr_b16 v[80:81], v192 offset:32768
    v_mfma_f32_16x16x32_bf16 v[140:143], v[100:103], v[76:79], v[140:143]
    ds_read_b64_tr_b16 v[82:83], v192 offset:33792
    v_mfma_f32_16x16x32_bf16 v[144:147], v[104:107], v[72:75], v[144:147]
    ds_read_b64_tr_b16 v[84:85], v193 offset:32768
    v_mfma_f32_16x16x32_bf16 v[148:151], v[104:107], v[76:79], v[148:151]
    ds_read_b64_tr_b16 v[86:87], v193 offset:33792
    v_mfma_f32_16x16x32_bf16 v[152:155], v[108:111], v[72:75], v[152:155]
    ds_read_b64_tr_b16 v[88:89], v194 offset:32768
    v_mfma_f32_16x16x32_bf16 v[156:159], v[108:111], v[76:79], v[156:159]
    ds_read_b64_tr_b16 v[90:91], v194 offset:33792
    v_mfma_f32_16x16x32_bf16 v[40:43], v[56:59], v[72:75], v[40:43]
    ds_read_b64_tr_b16 v[92:93], v195 offset:32768
    v_mfma_f32_16x16x32_bf16 v[44:47], v[72:75], v[72:75], v[44:47]
    s_lshl_b32 s66, s50, 7
    s_mul_i32 s67, s50, 176128
    s_add_u32 s50, s50, 1
    s_and_b32 s50, s50, 7
    s_add_u32 m0, s46, 0
    s_nop 0
    buffer_load_dwordx4 v6, s[8:11], s66 offen lds
    ds_read_b64_tr_b16 v[94:95], v195 offset:33792
    v_mfma_f32_16x16x32_bf16 v[112:115], v[96:99], v[56:59], v[112:115]
    s_add_u32 m0, s46, 1024
    s_nop 0
    buffer_load_dwordx4 v7, s[8:11], s66 offen lds
    s_waitcnt lgkmcnt(0)
    v_mfma_f32_16x16x32_bf16 v[128:131], v[80:83], v[64:67], v[128:131]
    ds_read_b128 v[72:75], v118 offset:32768
    v_mfma_f32_16x16x32_bf16 v[132:135], v[80:83], v[68:71], v[132:135]
    ds_read_b128 v[76:79], v119 offset:32768
    v_mfma_f32_16x16x32_bf16 v[136:139], v[84:87], v[64:67], v[136:139]
    ds_read_b64_tr_b16 v[96:97], v192 offset:40960
    v_mfma_f32_16x16x32_bf16 v[140:143], v[84:87], v[68:71], v[140:143]
    ds_read_b64_tr_b16 v[98:99], v192 offset:41984
    v_mfma_f32_16x16x32_bf16 v[144:147], v[88:91], v[64:67], v[144:147]
    ds_read_b64_tr_b16 v[100:101], v193 offset:40960
    v_mfma_f32_16x16x32_bf16 v[148:151], v[88:91], v[68:71], v[148:151]
    ds_read_b64_tr_b16 v[102:103], v193 offset:41984
    v_mfma_f32_16x16x32_bf16 v[152:155], v[92:95], v[64:67], v[152:155]
    ds_read_b64_tr_b16 v[104:105], v194 offset:40960
    v_mfma_f32_16x16x32_bf16 v[156:159], v[92:95], v[68:71], v[156:159]
    ds_read_b64_tr_b16 v[106:107], v194 offset:41984
    v_mfma_f32_16x16x32_bf16 v[40:43], v[56:59], v[64:67], v[40:43]
    ds_read_b64_tr_b16 v[108:109], v195 offset:40960
    v_mfma_f32_16x16x32_bf16 v[44:47], v[64:67], v[64:67], v[44:47]
    s_add_u32 m0, s46, 16384
    s_nop 0
    buffer_load_dwordx4 v8, s[12:15], s67 offen lds
    ds_read_b64_tr_b16 v[110:111], v195 offset:41984
    v_mfma_f32_16x16x32_bf16 v[112:115], v[80:83], v[56:59], v[112:115]
    s_add_u32 m0, s46, 17408
    s_add_u32 s67, s67, 11008
    buffer_load_dwordx4 v8, s[12:15], s67 offen lds
    s_waitcnt lgkmcnt(0)
    s_waitcnt vmcnt(8)
    s_barrier
    s_or_b32 s52, s2, s3
    s_cmp_lg_u32 s52, 0
    s_cbranch_scc1 L_noinit2
    v_mov_b32 v9, 0
    v_mov_b32 v15, 1
    s_mov_b64 exec, 1
    buffer_store_dword v15, v9, s[36:39], 0 offen sc1
    s_mov_b64 exec, -1
L_noinit2:
    v_mfma_f32_16x16x32_bf16 v[128:131], v[96:99], v[72:75], v[128:131]
    ds_read_b128 v[64:67], v120 offset:0
    v_mfma_f32_16x16x32_bf16 v[132:135], v[96:99], v[76:79], v[132:135]
    ds_read_b128 v[68:71], v121 offset:0
    v_mfma_f32_16x16x32_bf16 v[136:139], v[100:103], v[72:75], v[136:139]
    ds_read_b64_tr_b16 v[80:81], v196 offset:0
    v_mfma_f32_16x16x32_bf16 v[140:143], v[100:103], v[76:79], v[140:143]
    ds_read_b64_tr_b16 v[82:83], v196 offset:1024
    v_mfma_f32_16x16x32_bf16 v[144:147], v[104:107], v[72:75], v[144:147]
    ds_read_b64_tr_b16 v[84:85], v197 offset:0
    v_mfma_f32_16x16x32_bf16 v[148:151], v[104:107], v[76:79], v[148:151]
    ds_read_b64_tr_b16 v[86:87], v197 offset:1024
    v_mfma_f32_16x16x32_bf16 v[152:155], v[108:111], v[72:75], v[152:155]
    ds_read_b64_tr_b16 v[88:89], v198 offset:0
    v_mfma_f32_16x16x32_bf16 v[156:159], v[108:111], v[76:79], v[156:159]
    ds_read_b64_tr_b16 v[90:91], v198 offset:1024
    v_mfma_f32_16x16x32_bf16 v[40:43], v[56:59], v[72:75], v[40:43]
    ds_read_b64_tr_b16 v[92:93], v199 offset:0
    v_mfma_f32_16x16x32_bf16 v[44:47], v[72:75], v[72:75], v[44:47]
    s_lshl_b32 s66, s50, 7
    s_mul_i32 s67, s50, 176128
    s_add_u32 s50, s50, 1
    s_and_b32 s50, s50, 7
    s_add_u32 m0, s46, 32768
    s_nop 0
    buffer_load_dwordx4 v6, s[8:11], s66 offen lds
    ds_read_b64_tr_b16 v[94:95], v199 offset:1024
    v_mfma_f32_16x16x32_bf16 v[112:115], v[96:99], v[56:59], v[112:115]
    s_add_u32 m0, s46, 33792
    s_nop 0
    buffer_load_dwordx4 v7, s[8:11], s66 offen lds
    s_waitcnt lgkmcnt(0)
    v_mfma_f32_16x16x32_bf16 v[128:131], v[80:83], v[64:67], v[128:131]
    ds_read_b128 v[72:75], v122 offset:0
    v_mfma_f32_16x16x32_bf16 v[132:135], v[80:83], v[68:71], v[132:135]
    ds_read_b128 v[76:79], v123 offset:0
    v_mfma_f32_16x16x32_bf16 v[136:139], v[84:87], v[64:67], v[136:139]
    ds_read_b64_tr_b16 v[96:97], v196 offset:8192
    v_mfma_f32_16x16x32_bf16 v[140:143], v[84:87], v[68:71], v[140:143]
    ds_read_b64_tr_b16 v[98:99], v196 offset:9216
    v_mfma_f32_16x16x32_bf16 v[144:147], v[88:91], v[64:67], v[144:147]
    ds_read_b64_tr_b16 v[100:101], v197 offset:8192
    v_mfma_f32_16x16x32_bf16 v[148:151], v[88:91], v[68:71], v[148:151]
    ds_read_b64_tr_b16 v[102:103], v197 offset:9216
    v_mfma_f32_16x16x32_bf16 v[152:155], v[92:95], v[64:67], v[152:155]
    ds_read_b64_tr_b16 v[104:105], v198 offset:8192
    v_mfma_f32_16x16x32_bf16 v[156:159], v[92:95], v[68:71], v[156:159]
    ds_read_b64_tr_b16 v[106:107], v198 offset:9216
    v_mfma_f32_16x16x32_bf16 v[40:43], v[56:59], v[64:67], v[40:43]
    ds_read_b64_tr_b16 v[108:109], v199 offset:8192
    v_mfma_f32_16x16x32_bf16 v[44:47], v[64:67], v[64:67], v[44:47]
    s_add_u32 m0, s46, 49152
    s_nop 0
    buffer_load_dwordx4 v8, s[12:15], s67 offen lds
    ds_read_b64_tr_b16 v[110:111], v199 offset:9216
    v_mfma_f32_16x16x32_bf16 v[112:115], v[80:83], v[56:59], v[112:115]
    s_add_u32 m0, s46, 50176
    s_add_u32 s67, s67, 11008
    buffer_load_dwordx4 v8, s[12:15], s67 offen lds
    s_waitcnt lgkmcnt(0)
    s_waitcnt vmcnt(8)
    s_barrier
    s_lshl_b32 s52, s7, 13
    s_lshl_b32 s53, s6, 10
    s_add_u32 s52, s52, s53
    s_add_u32 m0, s52, 131072
    s_nop 0
    buffer_load_dwordx4 v186, s[28:31], 0 offen lds
    s_mov_b32 s53, 526336
    v_mad_i32_i24 v187, v185, s53, v184
    s_add_u32 m0, s52, 135168
    s_nop 0
    buffer_load_dwordx4 v187, s[28:31], 0 offen lds
    v_mfma_f32_16x16x32_bf16 v[128:131], v[96:99], v[72:75], v[128:131]
    ds_read_b128 v[64:67], v120 offset:32768
    v_mfma_f32_16x16x32_bf16 v[132:135], v[96:99], v[76:79], v[132:135]
    ds_read_b128 v[68:71], v121 offset:32768
    v_mfma_f32_16x16x32_bf16 v[136:139], v[100:103], v[72:75], v[136:139]
    ds_read_b64_tr_b16 v[80:81], v196 offset:32768
    v_mfma_f32_16x16x32_bf16 v[140:143], v[100:103], v[76:79], v[140:143]
    ds_read_b64_tr_b16 v[82:83], v196 offset:33792
    v_mfma_f32_16x16x32_bf16 v[144:147], v[104:107], v[72:75], v[144:147]
    ds_read_b64_tr_b16 v[84:85], v197 offset:32768
    v_mfma_f32_16x16x32_bf16 v[148:151], v[104:107], v[76:79], v[148:151]
    ds_read_b64_tr_b16 v[86:87], v197 offset:33792
    v_mfma_f32_16x16x32_bf16 v[152:155], v[108:111], v[72:75], v[152:155]
    ds_read_b64_tr_b16 v[88:89], v198 offset:32768
    v_mfma_f32_16x16x32_bf16 v[156:159], v[108:111], v[76:79], v[156:159]
    ds_read_b64_tr_b16 v[90:91], v198 offset:33792
    v_mfma_f32_16x16x32_bf16 v[40:43], v[56:59], v[72:75], v[40:43]
    ds_read_b64_tr_b16 v[92:93], v199 offset:32768
    v_mfma_f32_16x16x32_bf16 v[44:47], v[72:75], v[72:75], v[44:47]
    s_lshl_b32 s66, s50, 7
    s_mul_i32 s67, s50, 176128
    s_add_u32 s50, s50, 1
    s_and_b32 s50, s50, 7
    s_add_u32 m0, s46, 65536
    s_nop 0
    buffer_load_dwordx4 v6, s[8:11], s66 offen lds
    ds_read_b64_tr_b16 v[94:95], v199 offset:33792
    v_mfma_f32_16x16x32_bf16 v[112:115], v[96:99], v[56:59], v[112:115]
    s_add_u32 m0, s46, 66560
    s_nop 0
    buffer_load_dwordx4 v7, s[8:11], s66 offen lds
    s_waitcnt lgkmcnt(0)
    v_mfma_f32_16x16x32_bf16 v[128:131], v[80:83], v[64:67], v[128:131]
    ds_read_b128 v[72:75], v122 offset:32768
    v_mfma_f32_16x16x32_bf16 v[132:135], v[80:83], v[68:71], v[132:135]
    ds_read_b128 v[76:79], v123 offset:32768
    v_mfma_f32_16x16x32_bf16 v[136:139], v[84:87], v[64:67], v[136:139]
    ds_read_b64_tr_b16 v[96:97], v196 offset:40960
    v_mfma_f32_16x16x32_bf16 v[140:143], v[84:87], v[68:71], v[140:143]
    ds_read_b64_tr_b16 v[98:99], v196 offset:41984
    v_mfma_f32_16x16x32_bf16 v[144:147], v[88:91], v[64:67], v[144:147]
    ds_read_b64_tr_b16 v[100:101], v197 offset:40960
    v_mfma_f32_16x16x32_bf16 v[148:151], v[88:91], v[68:71], v[148:151]
    ds_read_b64_tr_b16 v[102:103], v197 offset:41984
    v_mfma_f32_16x16x32_bf16 v[152:155], v[92:95], v[64:67], v[152:155]
    ds_read_b64_tr_b16 v[104:105], v198 offset:40960
    v_mfma_f32_16x16x32_bf16 v[156:159], v[92:95], v[68:71], v[156:159]
    ds_read_b64_tr_b16 v[106:107], v198 offset:41984
    v_mfma_f32_16x16x32_bf16 v[40:43], v[56:59], v[64:67], v[40:43]
    ds_read_b64_tr_b16 v[108:109], v199 offset:40960
    v_mfma_f32_16x16x32_bf16 v[44:47], v[64:67], v[64:67], v[44:47]
    s_add_u32 m0, s46, 81920
    s_nop 0
    buffer_load_dwordx4 v8, s[12:15], s67 offen lds
    ds_read_b64_tr_b16 v[110:111], v199 offset:41984
    v_mfma_f32_16x16x32_bf16 v[112:115], v[80:83], v[56:59], v[112:115]
    s_add_u32 m0, s46, 82944
    s_add_u32 s67, s67, 11008
    buffer_load_dwordx4 v8, s[12:15], s67 offen lds
    s_waitcnt lgkmcnt(0)
    s_waitcnt vmcnt(10)
    s_barrier
    v_mfma_f32_16x16x32_bf16 v[128:131], v[96:99], v[72:75], v[128:131]
    ds_read_b128 v[64:67], v116 offset:0
    v_mfma_f32_16x16x32_bf16 v[132:135], v[96:99], v[76:79], v[132:135]
    ds_read_b128 v[68:71], v117 offset:0
    v_mfma_f32_16x16x32_bf16 v[136:139], v[100:103], v[72:75], v[136:139]
    ds_read_b64_tr_b16 v[80:81], v192 offset:0
    v_mfma_f32_16x16x32_bf16 v[140:143], v[100:103], v[76:79], v[140:143]
    ds_read_b64_tr_b16 v[82:83], v192 offset:1024
    v_mfma_f32_16x16x32_bf16 v[144:147], v[104:107], v[72:75], v[144:147]
    ds_read_b64_tr_b16 v[84:85], v193 offset:0
    v_mfma_f32_16x16x32_bf16 v[148:151], v[104:107], v[76:79], v[148:151]
    ds_read_b64_tr_b16 v[86:87], v193 offset:1024
    v_mfma_f32_16x16x32_bf16 v[152:155], v[108:111], v[72:75], v[152:155]
    ds_read_b64_tr_b16 v[88:89], v194 offset:0
    v_mfma_f32_16x16x32_bf16 v[156:159], v[108:111], v[76:79], v[156:159]
    ds_read_b64_tr_b16 v[90:91], v194 offset:1024
    v_mfma_f32_16x16x32_bf16 v[40:43], v[56:59], v[72:75], v[40:43]
    ds_read_b64_tr_b16 v[92:93], v195 offset:0
    v_mfma_f32_16x16x32_bf16 v[44:47], v[72:75], v[72:75], v[44:47]
    s_lshl_b32 s66, s50, 7
    s_mul_i32 s67, s50, 176128
    s_add_u32 s50, s50, 1
    s_and_b32 s50, s50, 7
    s_add_u32 m0, s46, 98304
    s_nop 0
    buffer_load_dwordx4 v6, s[8:11], s66 offen lds
    ds_read_b64_tr_b16 v[94:95], v195 offset:1024
    v_mfma_f32_16x16x32_bf16 v[112:115], v[96:99], v[56:59], v[112:115]
    s_add_u32 m0, s46, 99328
    s_nop 0
    buffer_load_dwordx4 v7, s[8:11], s66 offen lds
    s_waitcnt lgkmcnt(0)
    v_mfma_f32_16x16x32_bf16 v[128:131], v[80:83], v[64:67], v[128:131]
    ds_read_b128 v[72:75], v118 offset:0
    v_mfma_f32_16x16x32_bf16 v[132:135], v[80:83], v[68:71], v[132:135]
    ds_read_b128 v[76:79], v119 offset:0
    v_mfma_f32_16x16x32_bf16 v[136:139], v[84:87], v[64:67], v[136:139]
    ds_read_b64_tr_b16 v[96:97], v192 offset:8192
    v_mfma_f32_16x16x32_bf16 v[140:143], v[84:87], v[68:71], v[140:143]
    ds_read_b64_tr_b16 v[98:99], v192 offset:9216
    v_mfma_f32_16x16x32_bf16 v[144:147], v[88:91], v[64:67], v[144:147]
    ds_read_b64_tr_b16 v[100:101], v193 offset:8192
    v_mfma_f32_16x16x32_bf16 v[148:151], v[88:91], v[68:71], v[148:151]
    ds_read_b64_tr_b16 v[102:103], v193 offset:9216
    v_mfma_f32_16x16x32_bf16 v[152:155], v[92:95], v[64:67], v[152:155]
    ds_read_b64_tr_b16 v[104:105], v194 offset:8192
    v_mfma_f32_16x16x32_bf16 v[156:159], v[92:95], v[68:71], v[156:159]
    ds_read_b64_tr_b16 v[106:107], v194 offset:9216
    v_mfma_f32_16x16x32_bf16 v[40:43], v[56:59], v[64:67], v[40:43]
    ds_read_b64_tr_b16 v[108:109], v195 offset:8192
    v_mfma_f32_16x16x32_bf16 v[44:47], v[64:67], v[64:67], v[44:47]
    s_add_u32 m0, s46, 114688
    s_nop 0
    buffer_load_dwordx4 v8, s[12:15], s67 offen lds
    ds_read_b64_tr_b16 v[110:111], v195 offset:9216
    v_mfma_f32_16x16x32_bf16 v[112:115], v[80:83], v[56:59], v[112:115]
    s_add_u32 m0, s46, 115712
    s_add_u32 s67, s67, 11008
    buffer_load_dwordx4 v8, s[12:15], s67 offen lds
    s_waitcnt lgkmcnt(0)
    s_waitcnt vmcnt(10)
    s_barrier
    s_and_b32 s53, s5, 3
    s_lshl_b32 s52, s5, 3
    s_add_u32 s52, s52, s3
    s_mov_b32 s55, 0
    s_mul_i32 s53, s4, 21
    s_add_u32 s53, s53, s52
    s_cmp_ge_u32 s53, 172
    s_cselect_b32 s54, 172, 0
    s_sub_u32 s53, s53, s54
    s_lshl_b32 s53, s53, 13
    s_add_u32 s53, s53, s55
    s_cmp_ge_u32 s52, 172
    s_cselect_b32 s53, 0x7f000000, s53
    buffer_load_dword v254, v244, s[16:19], s53 offen
    v_mfma_f32_16x16x32_bf16 v[128:131], v[96:99], v[72:75], v[128:131]
    ds_read_b128 v[64:67], v116 offset:32768
    v_mfma_f32_16x16x32_bf16 v[132:135], v[96:99], v[76:79], v[132:135]
    ds_read_b128 v[68:71], v117 offset:32768
    v_mfma_f32_16x16x32_bf16 v[136:139], v[100:103], v[72:75], v[136:139]
    ds_read_b64_tr_b16 v[80:81], v192 offset:32768
    v_mfma_f32_16x16x32_bf16 v[140:143], v[100:103], v[76:79], v[140:143]
    ds_read_b64_tr_b16 v[82:83], v192 offset:33792
    v_mfma_f32_16x16x32_bf16 v[144:147], v[104:107], v[72:75], v[144:147]
    ds_read_b64_tr_b16 v[84:85], v193 offset:32768
    v_mfma_f32_16x16x32_bf16 v[148:151], v[104:107], v[76:79], v[148:151]
    ds_read_b64_tr_b16 v[86:87], v193 offset:33792
    v_mfma_f32_16x16x32_bf16 v[152:155], v[108:111], v[72:75], v[152:155]
    ds_read_b64_tr_b16 v[88:89], v194 offset:32768
    v_mfma_f32_16x16x32_bf16 v[156:159], v[108:111], v[76:79], v[156:159]
    ds_read_b64_tr_b16 v[90:91], v194 offset:33792
    v_mfma_f32_16x16x32_bf16 v[40:43], v[56:59], v[72:75], v[40:43]
    ds_read_b64_tr_b16 v[92:93], v195 offset:32768
    v_mfma_f32_16x16x32_bf16 v[44:47], v[72:75], v[72:75], v[44:47]
    ds_read_b64_tr_b16 v[94:95], v195 offset:33792
    v_mfma_f32_16x16x32_bf16 v[112:115], v[96:99], v[56:59], v[112:115]
    s_waitcnt lgkmcnt(0)
    v_mfma_f32_16x16x32_bf16 v[128:131], v[80:83], v[64:67], v[128:131]
    ds_read_b128 v[72:75], v118 offset:32768
    v_mfma_f32_16x16x32_bf16 v[132:135], v[80:83], v[68:71], v[132:135]
    ds_read_b128 v[76:79], v119 offset:32768
    v_mfma_f32_16x16x32_bf16 v[136:139], v[84:87], v[64:67], v[136:139]
    ds_read_b64_tr_b16 v[96:97], v192 offset:40960
    v_mfma_f32_16x16x32_bf16 v[140:143], v[84:87], v[68:71], v[140:143]
    ds_read_b64_tr_b16 v[98:99], v192 offset:41984
    v_mfma_f32_16x16x32_bf16 v[144:147], v[88:91], v[64:67], v[144:147]
    ds_read_b64_tr_b16 v[100:101], v193 offset:40960
    v_mfma_f32_16x16x32_bf16 v[148:151], v[88:91], v[68:71], v[148:151]
    ds_read_b64_tr_b16 v[102:103], v193 offset:41984
    v_mfma_f32_16x16x32_bf16 v[152:155], v[92:95], v[64:67], v[152:155]
    ds_read_b64_tr_b16 v[104:105], v194 offset:40960
    v_mfma_f32_16x16x32_bf16 v[156:159], v[92:95], v[68:71], v[156:159]
    ds_read_b64_tr_b16 v[106:107], v194 offset:41984
    v_mfma_f32_16x16x32_bf16 v[40:43], v[56:59], v[64:67], v[40:43]
    ds_read_b64_tr_b16 v[108:109], v195 offset:40960
    v_mfma_f32_16x16x32_bf16 v[44:47], v[64:67], v[64:67], v[44:47]
    ds_read_b64_tr_b16 v[110:111], v195 offset:41984
    v_mfma_f32_16x16x32_bf16 v[112:115], v[80:83], v[56:59], v[112:115]
    s_waitcnt lgkmcnt(0)
    s_waitcnt vmcnt(5)
    s_barrier
    v_mfma_f32_16x16x32_bf16 v[128:131], v[96:99], v[72:75], v[128:131]
    ds_read_b128 v[64:67], v120 offset:0
    v_mfma_f32_16x16x32_bf16 v[132:135], v[96:99], v[76:79], v[132:135]
    ds_read_b128 v[68:71], v121 offset:0
    v_mfma_f32_16x16x32_bf16 v[136:139], v[100:103], v[72:75], v[136:139]
    ds_read_b64_tr_b16 v[80:81], v196 offset:0
    v_mfma_f32_16x16x32_bf16 v[140:143], v[100:103], v[76:79], v[140:143]
    ds_read_b64_tr_b16 v[82:83], v196 offset:1024
    v_mfma_f32_16x16x32_bf16 v[144:147], v[104:107], v[72:75], v[144:147]
    ds_read_b64_tr_b16 v[84:85], v197 offset:0
    v_mfma_f32_16x16x32_bf16 v[148:151], v[104:107], v[76:79], v[148:151]
    ds_read_b64_tr_b16 v[86:87], v197 offset:1024
    v_mfma_f32_16x16x32_bf16 v[152:155], v[108:111], v[72:75], v[152:155]
    ds_read_b64_tr_b16 v[88:89], v198 offset:0
    v_mfma_f32_16x16x32_bf16 v[156:159], v[108:111], v[76:79], v[156:159]
    ds_read_b64_tr_b16 v[90:91], v198 offset:1024
    v_mfma_f32_16x16x32_bf16 v[40:43], v[56:59], v[72:75], v[40:43]
    ds_read_b64_tr_b16 v[92:93], v199 offset:0
    v_mfma_f32_16x16x32_bf16 v[44:47], v[72:75], v[72:75], v[44:47]
    ds_read_b64_tr_b16 v[94:95], v199 offset:1024
    v_mfma_f32_16x16x32_bf16 v[112:115], v[96:99], v[56:59], v[112:115]
    s_waitcnt lgkmcnt(0)
    v_mfma_f32_16x16x32_bf16 v[128:131], v[80:83], v[64:67], v[128:131]
    ds_read_b128 v[72:75], v122 offset:0
    v_mfma_f32_16x16x32_bf16 v[132:135], v[80:83], v[68:71], v[132:135]
    ds_read_b128 v[76:79], v123 offset:0
    v_mfma_f32_16x16x32_bf16 v[136:139], v[84:87], v[64:67], v[136:139]
    ds_read_b64_tr_b16 v[96:97], v196 offset:8192
    v_mfma_f32_16x16x32_bf16 v[140:143], v[84:87], v[68:71], v[140:143]
    ds_read_b64_tr_b16 v[98:99], v196 offset:9216
    v_mfma_f32_16x16x32_bf16 v[144:147], v[88:91], v[64:67], v[144:147]
    ds_read_b64_tr_b16 v[100:101], v197 offset:8192
    v_mfma_f32_16x16x32_bf16 v[148:151], v[88:91], v[68:71], v[148:151]
    ds_read_b64_tr_b16 v[102:103], v197 offset:9216
    v_mfma_f32_16x16x32_bf16 v[152:155], v[92:95], v[64:67], v[152:155]
    ds_read_b64_tr_b16 v[104:105], v198 offset:8192
    v_mfma_f32_16x16x32_bf16 v[156:159], v[92:95], v[68:71], v[156:159]
    ds_read_b64_tr_b16 v[106:107], v198 offset:9216
    v_mfma_f32_16x16x32_bf16 v[40:43], v[56:59], v[64:67], v[40:43]
    ds_read_b64_tr_b16 v[108:109], v199 offset:8192
    v_mfma_f32_16x16x32_bf16 v[44:47], v[64:67], v[64:67], v[44:47]
    ds_read_b64_tr_b16 v[110:111], v199 offset:9216
    v_mfma_f32_16x16x32_bf16 v[112:115], v[80:83], v[56:59], v[112:115]
    s_waitcnt lgkmcnt(0)
    s_waitcnt vmcnt(1)
    s_barrier
    v_mfma_f32_16x16x32_bf16 v[128:131], v[96:99], v[72:75], v[128:131]
    ds_read_b128 v[64:67], v120 offset:32768
    v_mfma_f32_16x16x32_bf16 v[132:135], v[96:99], v[76:79], v[132:135]
    ds_read_b128 v[68:71], v121 offset:32768
    v_mfma_f32_16x16x32_bf16 v[136:139], v[100:103], v[72:75], v[136:139]
    ds_read_b64_tr_b16 v[80:81], v196 offset:32768
    v_mfma_f32_16x16x32_bf16 v[140:143], v[100:103], v[76:79], v[140:143]
    ds_read_b64_tr_b16 v[82:83], v196 offset:33792
    v_mfma_f32_16x16x32_bf16 v[144:147], v[104:107], v[72:75], v[144:147]
    ds_read_b64_tr_b16 v[84:85], v197 offset:32768
    v_mfma_f32_16x16x32_bf16 v[148:151], v[104:107], v[76:79], v[148:151]
    ds_read_b64_tr_b16 v[86:87], v197 offset:33792
    v_mfma_f32_16x16x32_bf16 v[152:155], v[108:111], v[72:75], v[152:155]
    ds_read_b64_tr_b16 v[88:89], v198 offset:32768
    v_mfma_f32_16x16x32_bf16 v[156:159], v[108:111], v[76:79], v[156:159]
    ds_read_b64_tr_b16 v[90:91], v198 offset:33792
    v_mfma_f32_16x16x32_bf16 v[40:43], v[56:59], v[72:75], v[40:43]
    ds_read_b64_tr_b16 v[92:93], v199 offset:32768
    v_mfma_f32_16x16x32_bf16 v[44:47], v[72:75], v[72:75], v[44:47]
    ds_read_b64_tr_b16 v[94:95], v199 offset:33792
    v_mfma_f32_16x16x32_bf16 v[112:115], v[96:99], v[56:59], v[112:115]
    s_waitcnt lgkmcnt(0)
    v_mfma_f32_16x16x32_bf16 v[128:131], v[80:83], v[64:67], v[128:131]
    ds_read_b128 v[72:75], v122 offset:32768
    v_mfma_f32_16x16x32_bf16 v[132:135], v[80:83], v[68:71], v[132:135]
    ds_read_b128 v[76:79], v123 offset:32768
    v_mfma_f32_16x16x32_bf16 v[136:139], v[84:87], v[64:67], v[136:139]
    ds_read_b64_tr_b16 v[96:97], v196 offset:40960
    v_mfma_f32_16x16x32_bf16 v[140:143], v[84:87], v[68:71], v[140:143]
    ds_read_b64_tr_b16 v[98:99], v196 offset:41984
    v_mfma_f32_16x16x32_bf16 v[144:147], v[88:91], v[64:67], v[144:147]
    ds_read_b64_tr_b16 v[100:101], v197 offset:40960
    v_mfma_f32_16x16x32_bf16 v[148:151], v[88:91], v[68:71], v[148:151]
    ds_read_b64_tr_b16 v[102:103], v197 offset:41984
    v_mfma_f32_16x16x32_bf16 v[152:155], v[92:95], v[64:67], v[152:155]
    ds_read_b64_tr_b16 v[104:105], v198 offset:40960
    v_mfma_f32_16x16x32_bf16 v[156:159], v[92:95], v[68:71], v[156:159]
    ds_read_b64_tr_b16 v[106:107], v198 offset:41984
    v_mfma_f32_16x16x32_bf16 v[40:43], v[56:59], v[64:67], v[40:43]
    ds_read_b64_tr_b16 v[108:109], v199 offset:40960
    v_mfma_f32_16x16x32_bf16 v[44:47], v[64:67], v[64:67], v[44:47]
    ds_read_b64_tr_b16 v[110:111], v199 offset:41984
    v_mfma_f32_16x16x32_bf16 v[112:115], v[80:83], v[56:59], v[112:115]
    s_waitcnt lgkmcnt(0)
    v_mfma_f32_16x16x32_bf16 v[40:43], v[56:59], v[72:75], v[40:43]
    v_mfma_f32_16x16x32_bf16 v[44:47], v[72:75], v[72:75], v[44:47]
    v_mfma_f32_16x16x32_bf16 v[112:115], v[96:99], v[56:59], v[112:115]
    v_mfma_f32_16x16x32_bf16 v[128:131], v[96:99], v[72:75], v[128:131]
    v_mfma_f32_16x16x32_bf16 v[132:135], v[96:99], v[76:79], v[132:135]
    v_mfma_f32_16x16x32_bf16 v[136:139], v[100:103], v[72:75], v[136:139]
    s_nop 3
    v_cndmask_b32 v17, v44, v45, s[58:59]
    v_cndmask_b32 v17, v17, v46, s[60:61]
    v_cndmask_b32 v17, v17, v47, s[62:63]
    v_mul_f32 v16, 0x3b000000, v40
    v_mul_f32 v17, 0x3b000000, v17
    v_mfma_f32_16x16x32_bf16 v[140:143], v[100:103], v[76:79], v[140:143]
    v_fma_f32 v17, -v16, v16, v17
    v_max_f32 v17, 0, v17
    v_cvt_pk_bf16_f32 v18, v16, v16
    v_lshlrev_b32 v16, 16, v18
    v_cvt_pk_bf16_f32 v18, v17, v17
    v_mfma_f32_16x16x32_bf16 v[144:147], v[104:107], v[72:75], v[144:147]
    v_lshlrev_b32 v17, 16, v18
    v_add_f32 v17, 0x3727c5ac, v17
    v_cvt_pk_bf16_f32 v18, v17, v17
    v_lshlrev_b32 v17, 16, v18
    v_sqrt_f32 v17, v17
    v_mfma_f32_16x16x32_bf16 v[148:151], v[104:107], v[76:79], v[148:151]
    v_cvt_pk_bf16_f32 v18, v17, v17
    v_lshlrev_b32 v17, 16, v18
    v_rcp_f32 v17, v17
    s_nop 0
    v_mul_f32 v17, 0xbfb8aa3b, v17
    s_lshl_b32 s52, s6, 7
    v_mfma_f32_16x16x32_bf16 v[152:155], v[108:111], v[72:75], v[152:155]
    s_lshl_b32 s53, s7, 6
    s_add_u32 s53, s53, s52
    s_add_u32 s53, s53, 147456
    v_lshl_add_u32 v12, v3, 2, s53
    s_lshl_b32 s53, s3, 6
    v_mfma_f32_16x16x32_bf16 v[156:159], v[108:111], v[76:79], v[156:159]
    s_add_u32 s53, s53, 148480
    v_lshl_add_u32 v13, v4, 4, s53
    s_mov_b64 exec, s[64:65]
    ds_write_b32 v12, v16
    ds_write_b32 v12, v17 offset:512
    s_mov_b64 exec, s[56:57]
    ds_write_b128 v13, v[112:115]
    s_mov_b64 exec, -1
    s_waitcnt lgkmcnt(0)
    s_barrier
    v_mov_b32 v9, 0
    v_mov_b32 v10, 149504
    ds_write_b32 v10, v9
    ds_write_b32 v10, v9 offset:4
    ds_write_b32 v10, v9 offset:8
    ds_write_b32 v10, v9 offset:12
    ds_write_b32 v10, v9 offset:16
    buffer_load_dword v246, v9, s[36:39], 0 offen sc1
    s_mov_b32 s52, s75
    s_lshl_b32 s52, s52, 17
    s_min_u32 s52, s52, s77
    s_add_u32 m0, s73, 81920
    s_nop 0
    buffer_load_dwordx4 v247, s[16:19], s52 offen lds
    s_add_u32 s52, s52, 8192
    s_add_u32 m0, s73, 82944
    s_nop 0
    buffer_load_dwordx4 v247, s[16:19], s52 offen lds
    s_add_u32 s52, s75, 1
    s_cmp_ge_u32 s52, 11
    s_cselect_b32 s53, 11, 0
    s_sub_u32 s52, s52, s53
    s_lshl_b32 s52, s52, 17
    s_min_u32 s52, s52, s77
    s_add_u32 m0, s73, 98304
    s_nop 0
    buffer_load_dwordx4 v247, s[16:19], s52 offen lds
    s_add_u32 s52, s52, 8192
    s_add_u32 m0, s73, 99328
    s_nop 0
    buffer_load_dwordx4 v247, s[16:19], s52 offen lds
    v_xor_b32 v14, 64, v12
    ds_read_b32 v60, v12
    ds_read_b32 v48, v12 offset:512
    ds_read_b32 v62, v14
    ds_read_b32 v50, v14 offset:512
    v_xor_b32 v15, 0, v13
    ds_read_b128 v[80:83], v15
    v_xor_b32 v15, 64, v13
    ds_read_b128 v[84:87], v15
    v_xor_b32 v15, 128, v13
    ds_read_b128 v[88:91], v15
    v_xor_b32 v15, 192, v13
    ds_read_b128 v[92:95], v15
    s_lshl_b32 s52, s45, 1
    s_add_u32 s52, s52, s7
    s_xor_b32 s53, s52, 1
    s_mul_i32 s52, s52, 44
    s_mul_i32 s53, s53, 44
    s_lshl_b32 s54, s44, 2
    s_lshl_b32 s55, s7, 1
    s_add_u32 s54, s54, s55
    s_lshr_b32 s55, s6, 1
    s_add_u32 s40, s54, s55
    s_xor_b32 s55, s55, 1
    s_add_u32 s41, s54, s55
    s_add_u32 s76, s52, s40
    s_lshl_b32 s64, s76, 10
    s_add_u32 s76, s53, s40
    s_lshl_b32 s65, s76, 10
    s_add_u32 s76, s52, s41
    s_lshl_b32 s66, s76, 10
    s_add_u32 s76, s53, s41
    s_lshl_b32 s67, s76, 10
    s_mov_b32 s54, s40
    s_mov_b32 s55, s41
    s_and_b32 s40, s6, 1
    s_sub_u32 s40, 0, s40
    s_mov_b32 s41, s40
    s_waitcnt lgkmcnt(0)
    v_pk_fma_f32 v[128:129], v[60:61], v[80:81], v[128:129] op_sel_hi:[0,1,1] neg_lo:[1,0,0] neg_hi:[1,0,0]
    v_pk_fma_f32 v[130:131], v[60:61], v[82:83], v[130:131] op_sel_hi:[0,1,1] neg_lo:[1,0,0] neg_hi:[1,0,0]
    v_pk_fma_f32 v[136:137], v[60:61], v[84:85], v[136:137] op_sel_hi:[0,1,1] neg_lo:[1,0,0] neg_hi:[1,0,0]
    v_pk_fma_f32 v[138:139], v[60:61], v[86:87], v[138:139] op_sel_hi:[0,1,1] neg_lo:[1,0,0] neg_hi:[1,0,0]
    v_pk_mul_f32 v[128:129], v[128:129], v[48:49] op_sel_hi:[1,0]
    v_pk_mul_f32 v[130:131], v[130:131], v[48:49] op_sel_hi:[1,0]
    v_pk_mul_f32 v[136:137], v[136:137], v[48:49] op_sel_hi:[1,0]
    v_pk_mul_f32 v[138:139], v[138:139], v[48:49] op_sel_hi:[1,0]
    v_exp_f32 v16, v128
    v_exp_f32 v17, v129
    v_exp_f32 v18, v130
    v_exp_f32 v19, v131
    v_exp_f32 v20, v136
    v_exp_f32 v21, v137
    v_exp_f32 v22, v138
    v_exp_f32 v23, v139
    v_pk_add_f32 v[16:17], v[16:17], 1.0 op_sel_hi:[1,0]
    v_pk_add_f32 v[18:19], v[18:19], 1.0 op_sel_hi:[1,0]
    v_pk_add_f32 v[20:21], v[20:21], 1.0 op_sel_hi:[1,0]
    v_pk_add_f32 v[22:23], v[22:23], 1.0 op_sel_hi:[1,0]
    v_rcp_f32 v16, v16
    v_rcp_f32 v17, v17
    v_rcp_f32 v18, v18
    v_rcp_f32 v19, v19
    v_rcp_f32 v20, v20
    v_rcp_f32 v21, v21
    v_rcp_f32 v22, v22
    v_rcp_f32 v23, v23
    v_pk_mul_f32 v[128:129], v[128:129], v[16:17]
    v_pk_mul_f32 v[130:131], v[130:131], v[18:19]
    v_pk_mul_f32 v[136:137], v[136:137], v[20:21]
    v_pk_mul_f32 v[138:139], v[138:139], v[22:23]
    v_cvt_pk_bf16_f32 v64, v128, v129
    v_cvt_pk_bf16_f32 v65, v130, v131
    v_cvt_pk_bf16_f32 v66, v136, v137
    v_cvt_pk_bf16_f32 v67, v138, v139
    s_mov_b64 exec, s[40:41]
    v_swap_b32 v64, v66
    v_swap_b32 v65, v67
    s_mov_b64 exec, -1
    s_cmp_lg_u32 s54, 43
    s_cbranch_scc1 L_hz00
    v_mov_b64 v[64:65], 0
    v_mov_b64 v[66:67], 0
L_hz00:
    buffer_store_dwordx4 v[64:67], v5, s[20:23], s64 offen sc1
    v_pk_fma_f32 v[132:133], v[62:63], v[80:81], v[132:133] op_sel_hi:[0,1,1] neg_lo:[1,0,0] neg_hi:[1,0,0]
    v_pk_fma_f32 v[134:135], v[62:63], v[82:83], v[134:135] op_sel_hi:[0,1,1] neg_lo:[1,0,0] neg_hi:[1,0,0]
    v_pk_fma_f32 v[140:141], v[62:63], v[84:85], v[140:141] op_sel_hi:[0,1,1] neg_lo:[1,0,0] neg_hi:[1,0,0]
    v_pk_fma_f32 v[142:143], v[62:63], v[86:87], v[142:143] op_sel_hi:[0,1,1] neg_lo:[1,0,0] neg_hi:[1,0,0]
    v_pk_mul_f32 v[132:133], v[132:133], v[50:51] op_sel_hi:[1,0]
    v_pk_mul_f32 v[134:135], v[134:135], v[50:51] op_sel_hi:[1,0]
    v_pk_mul_f32 v[140:141], v[140:141], v[50:51] op_sel_hi:[1,0]
    v_pk_mul_f32 v[142:143], v[142:143], v[50:51] op_sel_hi:[1,0]
    v_exp_f32 v24, v132
    v_exp_f32 v25, v133
    v_exp_f32 v26, v134
    v_exp_f32 v27, v135
    v_exp_f32 v28, v140
    v_exp_f32 v29, v141
    v_exp_f32 v30, v142
    v_exp_f32 v31, v143
    v_pk_add_f32 v[24:25], v[24:25], 1.0 op_sel_hi:[1,0]
    v_pk_add_f32 v[26:27], v[26:27], 1.0 op_sel_hi:[1,0]
    v_pk_add_f32 v[28:29], v[28:29], 1.0 op_sel_hi:[1,0]
    v_pk_add_f32 v[30:31], v[30:31], 1.0 op_sel_hi:[1,0]
    v_rcp_f32 v24, v24
    v_rcp_f32 v25, v25
    v_rcp_f32 v26, v26
    v_rcp_f32 v27, v27
    v_rcp_f32 v28, v28
    v_rcp_f32 v29, v29
    v_rcp_f32 v30, v30
    v_rcp_f32 v31, v31
    v_pk_mul_f32 v[132:133], v[132:133], v[24:25]
    v_pk_mul_f32 v[134:135], v[134:135], v[26:27]
    v_pk_mul_f32 v[140:141], v[140:141], v[28:29]
    v_pk_mul_f32 v[142:143], v[142:143], v[30:31]
    v_cvt_pk_bf16_f32 v68, v132, v133
    v_cvt_pk_bf16_f32 v69, v134, v135
    v_cvt_pk_bf16_f32 v70, v140, v141
    v_cvt_pk_bf16_f32 v71, v142, v143
    s_mov_b64 exec, s[40:41]
    v_swap_b32 v68, v70
    v_swap_b32 v69, v71
    s_mov_b64 exec, -1
    s_cmp_lg_u32 s54, 43
    s_cbranch_scc1 L_hz01
    v_mov_b64 v[68:69], 0
    v_mov_b64 v[70:71], 0
L_hz01:
    buffer_store_dwordx4 v[68:71], v5, s[20:23], s65 offen sc1
    v_pk_fma_f32 v[144:145], v[60:61], v[88:89], v[144:145] op_sel_hi:[0,1,1] neg_lo:[1,0,0] neg_hi:[1,0,0]
    v_pk_fma_f32 v[146:147], v[60:61], v[90:91], v[146:147] op_sel_hi:[0,1,1] neg_lo:[1,0,0] neg_hi:[1,0,0]
    v_pk_fma_f32 v[152:153], v[60:61], v[92:93], v[152:153] op_sel_hi:[0,1,1] neg_lo:[1,0,0] neg_hi:[1,0,0]
    v_pk_fma_f32 v[154:155], v[60:61], v[94:95], v[154:155] op_sel_hi:[0,1,1] neg_lo:[1,0,0] neg_hi:[1,0,0]
    v_pk_mul_f32 v[144:145], v[144:145], v[48:49] op_sel_hi:[1,0]
    v_pk_mul_f32 v[146:147], v[146:147], v[48:49] op_sel_hi:[1,0]
    v_pk_mul_f32 v[152:153], v[152:153], v[48:49] op_sel_hi:[1,0]
    v_pk_mul_f32 v[154:155], v[154:155], v[48:49] op_sel_hi:[1,0]
    v_exp_f32 v16, v144
    v_exp_f32 v17, v145
    v_exp_f32 v18, v146
    v_exp_f32 v19, v147
    v_exp_f32 v20, v152
    v_exp_f32 v21, v153
    v_exp_f32 v22, v154
    v_exp_f32 v23, v155
    v_pk_add_f32 v[16:17], v[16:17], 1.0 op_sel_hi:[1,0]
    v_pk_add_f32 v[18:19], v[18:19], 1.0 op_sel_hi:[1,0]
    v_pk_add_f32 v[20:21], v[20:21], 1.0 op_sel_hi:[1,0]
    v_pk_add_f32 v[22:23], v[22:23], 1.0 op_sel_hi:[1,0]
    v_rcp_f32 v16, v16
    v_rcp_f32 v17, v17
    v_rcp_f32 v18, v18
    v_rcp_f32 v19, v19
    v_rcp_f32 v20, v20
    v_rcp_f32 v21, v21
    v_rcp_f32 v22, v22
    v_rcp_f32 v23, v23
    v_pk_mul_f32 v[144:145], v[144:145], v[16:17]
    v_pk_mul_f32 v[146:147], v[146:147], v[18:19]
    v_pk_mul_f32 v[152:153], v[152:153], v[20:21]
    v_pk_mul_f32 v[154:155], v[154:155], v[22:23]
    v_cvt_pk_bf16_f32 v72, v144, v145
    v_cvt_pk_bf16_f32 v73, v146, v147
    v_cvt_pk_bf16_f32 v74, v152, v153
    v_cvt_pk_bf16_f32 v75, v154, v155
    s_mov_b64 exec, s[40:41]
    v_swap_b32 v72, v74
    v_swap_b32 v73, v75
    s_mov_b64 exec, -1
    s_cmp_lg_u32 s55, 43
    s_cbranch_scc1 L_hz10
    v_mov_b64 v[72:73], 0
    v_mov_b64 v[74:75], 0
L_hz10:
    buffer_store_dwordx4 v[72:75], v5, s[20:23], s66 offen sc1
    v_pk_fma_f32 v[148:149], v[62:63], v[88:89], v[148:149] op_sel_hi:[0,1,1] neg_lo:[1,0,0] neg_hi:[1,0,0]
    v_pk_fma_f32 v[150:151], v[62:63], v[90:91], v[150:151] op_sel_hi:[0,1,1] neg_lo:[1,0,0] neg_hi:[1,0,0]
    v_pk_fma_f32 v[156:157], v[62:63], v[92:93], v[156:157] op_sel_hi:[0,1,1] neg_lo:[1,0,0] neg_hi:[1,0,0]
    v_pk_fma_f32 v[158:159], v[62:63], v[94:95], v[158:159] op_sel_hi:[0,1,1] neg_lo:[1,0,0] neg_hi:[1,0,0]
    v_pk_mul_f32 v[148:149], v[148:149], v[50:51] op_sel_hi:[1,0]
    v_pk_mul_f32 v[150:151], v[150:151], v[50:51] op_sel_hi:[1,0]
    v_pk_mul_f32 v[156:157], v[156:157], v[50:51] op_sel_hi:[1,0]
    v_pk_mul_f32 v[158:159], v[158:159], v[50:51] op_sel_hi:[1,0]
    v_exp_f32 v24, v148
    v_exp_f32 v25, v149
    v_exp_f32 v26, v150
    v_exp_f32 v27, v151
    v_exp_f32 v28, v156
    v_exp_f32 v29, v157
    v_exp_f32 v30, v158
    v_exp_f32 v31, v159
    v_pk_add_f32 v[24:25], v[24:25], 1.0 op_sel_hi:[1,0]
    v_pk_add_f32 v[26:27], v[26:27], 1.0 op_sel_hi:[1,0]
    v_pk_add_f32 v[28:29], v[28:29], 1.0 op_sel_hi:[1,0]
    v_pk_add_f32 v[30:31], v[30:31], 1.0 op_sel_hi:[1,0]
    v_rcp_f32 v24, v24
    v_rcp_f32 v25, v25
    v_rcp_f32 v26, v26
    v_rcp_f32 v27, v27
    v_rcp_f32 v28, v28
    v_rcp_f32 v29, v29
    v_rcp_f32 v30, v30
    v_rcp_f32 v31, v31
    v_pk_mul_f32 v[148:149], v[148:149], v[24:25]
    v_pk_mul_f32 v[150:151], v[150:151], v[26:27]
    v_pk_mul_f32 v[156:157], v[156:157], v[28:29]
    v_pk_mul_f32 v[158:159], v[158:159], v[30:31]
    v_cvt_pk_bf16_f32 v76, v148, v149
    v_cvt_pk_bf16_f32 v77, v150, v151
    v_cvt_pk_bf16_f32 v78, v156, v157
    v_cvt_pk_bf16_f32 v79, v158, v159
    s_mov_b64 exec, s[40:41]
    v_swap_b32 v76, v78
    v_swap_b32 v77, v79
    s_mov_b64 exec, -1
    s_cmp_lg_u32 s55, 43
    s_cbranch_scc1 L_hz11
    v_mov_b64 v[76:77], 0
    v_mov_b64 v[78:79], 0
L_hz11:
    buffer_store_dwordx4 v[76:79], v5, s[20:23], s67 offen sc1
    s_nop 1
    s_branch L_F_end
L_g1_S:
    s_lshl_b32 s52, s50, 7
    s_add_u32 s50, s50, 1
    s_and_b32 s50, s50, 7
    s_lshl_b32 s52, s50, 7
    s_add_u32 m0, s46, 49152
    s_nop 0
    buffer_load_dwordx4 v6, s[8:11], s52 offen lds
    s_add_u32 m0, s46, 50176
    s_nop 0
    buffer_load_dwordx4 v7, s[8:11], s52 offen lds
    s_add_u32 s50, s50, 1
    s_and_b32 s50, s50, 7
    s_lshl_b32 s52, s50, 7
    s_add_u32 m0, s46, 65536
    s_nop 0
    buffer_load_dwordx4 v6, s[8:11], s52 offen lds
    s_add_u32 m0, s46, 66560
    s_nop 0
    buffer_load_dwordx4 v7, s[8:11], s52 offen lds
    s_add_u32 s50, s50, 1
    s_and_b32 s50, s50, 7
    s_and_b32 s21, s21, 0xffff
    s_and_b32 s17, s17, 0xffff
    s_and_b32 s29, s29, 0xffff
    s_and_b32 s33, s33, 0xffff
    s_and_b32 s25, s25, 0xffff
    s_and_b32 s37, s37, 0xffff
    v_lshrrev_b32 v10, 2, v3
    v_lshl_add_u32 v10, v4, 2, v10
    v_and_b32 v11, 7, v10
    v_and_b32 v12, 3, v2
    v_lshrrev_b32 v13, 1, v12
    v_xor_b32 v11, v11, v13
    s_lshl_b32 s52, s7, 2
    v_xor_b32 v11, s52, v11
    v_and_b32 v12, 1, v12
    v_lshlrev_b32 v10, 7, v10
    v_lshl_add_u32 v10, v12, 3, v10
    v_lshl_add_u32 v10, v11, 4, v10
    s_and_b32 s52, s4, 2
    s_lshl_b32 s52, s52, 13
    v_add_u32 v192, s52, v10
    v_xor_b32 v193, 32, v192
    v_xor_b32 v194, 16384, v192
    v_xor_b32 v195, 16384, v193
    v_lshrrev_b32 v10, 1, v3
    v_xor_b32 v10, v10, v4
    s_lshl_b32 s52, s6, 12
    s_lshl_b32 s53, s7, 11
    s_add_u32 s52, s52, s53
    s_add_u32 s52, s52, 32768
    v_lshlrev_b32 v11, 7, v3
    v_lshl_add_u32 v11, v10, 4, v11
    v_add_u32 v200, s52, v11
    v_xor_b32 v201, 2048, v200
    v_xor_b32 v202, 64, v200
    v_xor_b32 v203, 64, v201
    v_add_u32 v204, 0x10000, v200
    v_add_u32 v205, 0x10000, v201
    v_add_u32 v206, 0x10000, v202
    v_add_u32 v207, 0x10000, v203
    v_cmp_eq_u32 s[56:57], 0, v3
    v_and_b32 v10, 3, v3
    v_cmp_eq_u32 s[58:59], 1, v10
    v_cmp_eq_u32 s[60:61], 2, v10
    v_cmp_eq_u32 s[62:63], 3, v10
    v_lshrrev_b32 v10, 2, v3
    v_cmp_eq_u32 s[64:65], v10, v4
    v_mov_b32 v56, 0x3f803f80
    v_mov_b32 v57, 0x3f803f80
    v_mov_b32 v58, 0x3f803f80
    v_mov_b32 v59, 0x3f803f80
    s_mov_b32 s66, 0x05040100
    s_mov_b32 s67, 0x07060302
    v_and_b32 v9, 255, v0
    s_sub_u32 s55, s44, 11
    s_lshl_b32 s55, s55, 5
    s_lshl_b32 s52, s7, 4
    s_add_u32 s55, s55, s52
    v_and_b32 v11, 7, v9
    s_lshl_b32 s52, s7, 2
    v_xor_b32 v11, s52, v11
    v_lshlrev_b32 v11, 4, v11
    v_lshl_add_u32 v11, v9, 7, v11
    v_cvt_f32_u32 v10, v9
    v_mul_f32 v10, 0x3b800000, v10
    v_cos_f32 v12, v10
    v_sin_f32 v13, v10
    v_mul_u32_u24 v14, s55, v9
    v_and_b32 v14, 255, v14
    v_cvt_f32_u32 v14, v14
    v_mul_f32 v14, 0x3b800000, v14
    v_cos_f32 v16, v14
    v_sin_f32 v17, v14
    s_nop 0
    v_pk_mul_f32 v[20:21], v[16:17], v[12:13] op_sel_hi:[1,0]
    v_pk_fma_f32 v[18:19], v[16:17], v[12:13], v[20:21] op_sel:[1,1,0] op_sel_hi:[0,1,1] neg_lo:[1,0,0]
    v_pk_mul_f32 v[20:21], v[18:19], v[12:13] op_sel_hi:[1,0]
    v_cvt_pk_bf16_f32 v64, v16, v18
    v_cvt_pk_bf16_f32 v72, -v17, -v19
    v_pk_fma_f32 v[16:17], v[18:19], v[12:13], v[20:21] op_sel:[1,1,0] op_sel_hi:[0,1,1] neg_lo:[1,0,0]
    v_pk_mul_f32 v[20:21], v[16:17], v[12:13] op_sel_hi:[1,0]
    v_pk_fma_f32 v[18:19], v[16:17], v[12:13], v[20:21] op_sel:[1,1,0] op_sel_hi:[0,1,1] neg_lo:[1,0,0]
    v_pk_mul_f32 v[20:21], v[18:19], v[12:13] op_sel_hi:[1,0]
    v_cvt_pk_bf16_f32 v65, v16, v18
    v_cvt_pk_bf16_f32 v73, -v17, -v19
    v_pk_fma_f32 v[16:17], v[18:19], v[12:13], v[20:21] op_sel:[1,1,0] op_sel_hi:[0,1,1] neg_lo:[1,0,0]
    v_pk_mul_f32 v[20:21], v[16:17], v[12:13] op_sel_hi:[1,0]
    v_pk_fma_f32 v[18:19], v[16:17], v[12:13], v[20:21] op_sel:[1,1,0] op_sel_hi:[0,1,1] neg_lo:[1,0,0]
    v_pk_mul_f32 v[20:21], v[18:19], v[12:13] op_sel_hi:[1,0]
    v_cvt_pk_bf16_f32 v66, v16, v18
    v_cvt_pk_bf16_f32 v74, -v17, -v19
    v_pk_fma_f32 v[16:17], v[18:19], v[12:13], v[20:21] op_sel:[1,1,0] op_sel_hi:[0,1,1] neg_lo:[1,0,0]
    v_pk_mul_f32 v[20:21], v[16:17], v[12:13] op_sel_hi:[1,0]
    v_pk_fma_f32 v[18:19], v[16:17], v[12:13], v[20:21] op_sel:[1,1,0] op_sel_hi:[0,1,1] neg_lo:[1,0,0]
    v_pk_mul_f32 v[20:21], v[18:19], v[12:13] op_sel_hi:[1,0]
    v_cvt_pk_bf16_f32 v67, v16, v18
    v_cvt_pk_bf16_f32 v75, -v17, -v19
    v_pk_fma_f32 v[16:17], v[18:19], v[12:13], v[20:21] op_sel:[1,1,0] op_sel_hi:[0,1,1] neg_lo:[1,0,0]
    v_pk_mul_f32 v[20:21], v[16:17], v[12:13] op_sel_hi:[1,0]
    v_pk_fma_f32 v[18:19], v[16:17], v[12:13], v[20:21] op_sel:[1,1,0] op_sel_hi:[0,1,1] neg_lo:[1,0,0]
    v_pk_mul_f32 v[20:21], v[18:19], v[12:13] op_sel_hi:[1,0]
    v_cvt_pk_bf16_f32 v68, v16, v18
    v_cvt_pk_bf16_f32 v76, -v17, -v19
    v_pk_fma_f32 v[16:17], v[18:19], v[12:13], v[20:21] op_sel:[1,1,0] op_sel_hi:[0,1,1] neg_lo:[1,0,0]
    v_pk_mul_f32 v[20:21], v[16:17], v[12:13] op_sel_hi:[1,0]
    v_pk_fma_f32 v[18:19], v[16:17], v[12:13], v[20:21] op_sel:[1,1,0] op_sel_hi:[0,1,1] neg_lo:[1,0,0]
    v_pk_mul_f32 v[20:21], v[18:19], v[12:13] op_sel_hi:[1,0]
    v_cvt_pk_bf16_f32 v69, v16, v18
    v_cvt_pk_bf16_f32 v77, -v17, -v19
    v_pk_fma_f32 v[16:17], v[18:19], v[12:13], v[20:21] op_sel:[1,1,0] op_sel_hi:[0,1,1] neg_lo:[1,0,0]
    v_pk_mul_f32 v[20:21], v[16:17], v[12:13] op_sel_hi:[1,0]
    v_pk_fma_f32 v[18:19], v[16:17], v[12:13], v[20:21] op_sel:[1,1,0] op_sel_hi:[0,1,1] neg_lo:[1,0,0]
    v_pk_mul_f32 v[20:21], v[18:19], v[12:13] op_sel_hi:[1,0]
    v_cvt_pk_bf16_f32 v70, v16, v18
    v_cvt_pk_bf16_f32 v78, -v17, -v19
    v_pk_fma_f32 v[16:17], v[18:19], v[12:13], v[20:21] op_sel:[1,1,0] op_sel_hi:[0,1,1] neg_lo:[1,0,0]
    v_pk_mul_f32 v[20:21], v[16:17], v[12:13] op_sel_hi:[1,0]
    v_pk_fma_f32 v[18:19], v[16:17], v[12:13], v[20:21] op_sel:[1,1,0] op_sel_hi:[0,1,1] neg_lo:[1,0,0]
    v_cvt_pk_bf16_f32 v71, v16, v18
    v_cvt_pk_bf16_f32 v79, -v17, -v19
    ds_write_b128 v11, v[64:67]
    v_xor_b32 v14, 16, v11
    ds_write_b128 v14, v[68:71]
    v_xor_b32 v14, 32, v11
    ds_write_b128 v14, v[72:75]
    v_xor_b32 v14, 48, v11
    ds_write_b128 v14, v[76:79]
    v_add_u32 v10, s55, v3
    v_cvt_f32_u32 v10, v10
    v_mul_f32 v10, 0x3b000000, v10
    v_cos_f32 v34, v10
    v_sin_f32 v48, v10
    v_cos_f32 v35, v10
    v_sin_f32 v49, v10
    s_lshl_b32 s52, s50, 7
    s_add_u32 m0, s46, 81920
    s_nop 0
    buffer_load_dwordx4 v6, s[8:11], s52 offen lds
    s_add_u32 m0, s46, 82944
    s_nop 0
    buffer_load_dwordx4 v7, s[8:11], s52 offen lds
    s_add_u32 s50, s50, 1
    s_and_b32 s50, s50, 7
    s_cmp_ge_u32 s3, 4
    s_cselect_b32 s28, s32, s28
    s_cselect_b32 s29, s33, s29
    s_sub_u32 s54, s5, 22
    s_cmp_ge_u32 s54, 5
    s_cselect_b32 s52, 5, 0
    s_cselect_b32 s53, 2, 0
    s_sub_u32 s54, s54, s52
    s_lshl_b32 s54, s54, 7
    s_lshr_b32 s52, s6, 1
    s_add_u32 s52, s52, s53
    s_lshl_b32 s100, s4, 1
    s_lshr_b32 s53, s52, 1
    s_add_u32 s100, s100, s53
    s_sub_u32 s53, 32, s100
    s_cmp_eq_u32 s100, 0
    s_cselect_b32 s53, 16, s53
    s_bitcmp1_b32 s52, 0
    s_cselect_b32 s100, s53, s100
    s_and_b32 s52, s6, 1
    s_lshl_b32 s52, s52, 10
    s_add_u32 s52, s52, s100
    v_lshl_add_u32 v10, v2, 5, s52
    v_mul_u32_u24 v10, 514, v10
    s_mov_b32 exec_hi, 0
    buffer_load_ushort v254, v10, s[28:31], s54 offen
    s_mov_b32 exec_hi, -1
    s_lshl_b32 s76, s7, 10
    s_add_u32 s76, s76, s45
    s_cmp_eq_u32 s7, 0
    s_cselect_b32 s1, 0.5, -0.5
    v_add_u32 v10, 0, v3
    v_lshl_add_u32 v11, v4, 8, s76
    v_mul_u32_u24 v11, v10, v11
    v_and_b32 v11, 2047, v11
    v_cvt_f32_u32 v11, v11
    v_cvt_f32_u32 v10, v10
    v_mul_f32 v11, 0x3a000000, v11
    v_fma_f32 v13, v10, s1, v11
    v_mul_f32 v10, 0x3d000000, v10
    v_cos_f32 v16, v11
    v_sin_f32 v24, v11
    v_fmamk_f32 v12, v10, 0x3f800000, v11
    v_fract_f32 v12, v12
    v_cos_f32 v17, v12
    v_sin_f32 v25, v12
    v_fmamk_f32 v12, v10, 0x40000000, v11
    v_fract_f32 v12, v12
    v_cos_f32 v18, v12
    v_sin_f32 v26, v12
    v_fmamk_f32 v12, v10, 0x40400000, v11
    v_fract_f32 v12, v12
    v_cos_f32 v19, v12
    v_sin_f32 v27, v12
    v_fract_f32 v12, v13
    v_cos_f32 v20, v12
    v_sin_f32 v28, v12
    v_fmamk_f32 v12, v10, 0x3f800000, v13
    v_fract_f32 v12, v12
    v_cos_f32 v21, v12
    v_sin_f32 v29, v12
    v_fmamk_f32 v12, v10, 0x40000000, v13
    v_fract_f32 v12, v12
    v_cos_f32 v22, v12
    v_sin_f32 v30, v12
    v_fmamk_f32 v12, v10, 0x40400000, v13
    v_fract_f32 v12, v12
    v_cos_f32 v23, v12
    v_sin_f32 v31, v12
    v_cvt_pk_bf16_f32 v160, v16, v17
    v_cvt_pk_bf16_f32 v168, v24, v25
    v_cvt_pk_bf16_f32 v161, v18, v19
    v_cvt_pk_bf16_f32 v169, v26, v27
    v_cvt_pk_bf16_f32 v162, v20, v21
    v_cvt_pk_bf16_f32 v170, v28, v29
    v_cvt_pk_bf16_f32 v163, v22, v23
    v_cvt_pk_bf16_f32 v171, v30, v31
    v_cvt_f32_u32 v10, s45
    v_mul_f32 v10, 0x3c000000, v10
    v_cos_f32 v12, v10
    v_sin_f32 v14, v10
    v_xor_b32 v13, 0x80000000, v12
    v_xor_b32 v15, 0x80000000, v14
    v_pk_mul_f32 v[64:65], v[16:17], v[12:13]
    v_pk_mul_f32 v[72:73], v[24:25], v[12:13]
    v_pk_mul_f32 v[66:67], v[18:19], v[12:13]
    v_pk_mul_f32 v[74:75], v[26:27], v[12:13]
    v_pk_mul_f32 v[68:69], v[20:21], v[12:13]
    v_pk_mul_f32 v[76:77], v[28:29], v[12:13]
    v_pk_mul_f32 v[70:71], v[22:23], v[12:13]
    v_pk_mul_f32 v[78:79], v[30:31], v[12:13]
    v_pk_fma_f32 v[64:65], v[24:25], v[14:15], v[64:65] neg_lo:[1,0,0] neg_hi:[1,0,0]
    v_pk_fma_f32 v[72:73], v[16:17], v[14:15], v[72:73]
    v_pk_fma_f32 v[66:67], v[26:27], v[14:15], v[66:67] neg_lo:[1,0,0] neg_hi:[1,0,0]
    v_pk_fma_f32 v[74:75], v[18:19], v[14:15], v[74:75]
    v_pk_fma_f32 v[68:69], v[28:29], v[14:15], v[68:69] neg_lo:[1,0,0] neg_hi:[1,0,0]
    v_pk_fma_f32 v[76:77], v[20:21], v[14:15], v[76:77]
    v_pk_fma_f32 v[70:71], v[30:31], v[14:15], v[70:71] neg_lo:[1,0,0] neg_hi:[1,0,0]
    v_pk_fma_f32 v[78:79], v[22:23], v[14:15], v[78:79]
    v_cvt_pk_bf16_f32 v164, v64, v65
    v_cvt_pk_bf16_f32 v172, v72, v73
    v_cvt_pk_bf16_f32 v165, v66, v67
    v_cvt_pk_bf16_f32 v173, v74, v75
    v_cvt_pk_bf16_f32 v166, v68, v69
    v_cvt_pk_bf16_f32 v174, v76, v77
    v_cvt_pk_bf16_f32 v167, v70, v71
    v_cvt_pk_bf16_f32 v175, v78, v79
    s_mul_i32 s54, s5, 3
    s_cmp_ge_u32 s5, 27
    s_addc_u32 s54, s54, -66
    s_mov_b32 s42, 3
    s_lshl_b32 s49, s3, 12
    s_lshr_b32 s52, s54, 4
    s_and_b32 s55, s54, 15
    s_lshl_b32 s100, s4, 1
    s_lshr_b32 s53, s52, 1
    s_add_u32 s100, s100, s53
    s_sub_u32 s53, 32, s100
    s_cmp_eq_u32 s100, 0
    s_cselect_b32 s53, 16, s53
    s_bitcmp1_b32 s52, 0
    s_cselect_b32 s100, s53, s100
    s_add_u32 s47, s55, s3
    s_and_b32 s53, s100, 1
    s_lshl_b32 s53, s53, 1
    s_lshl_b32 s1, s3, 4
    s_add_u32 s1, s1, s53
    s_lshl_b32 s101, s42, 5
    s_add_u32 s101, s101, 32
    s_sub_u32 s101, s101, s1
    s_cmp_lt_u32 s3, s42
    s_cselect_b32 s48, 1, 0
    s_lshl_b32 s51, s47, 5
    s_add_u32 s51, s51, s100
    s_lshl_b32 s55, s55, 4
    s_sub_u32 s54, s55, s53
    s_lshl_b32 s52, s42, 5
    s_add_u32 s55, s55, s52
    s_sub_u32 s55, s53, s55
    s_add_u32 s55, s55, 1053168
    s_lshl_b32 s52, s6, 1
    v_xor_b32 v10, s52, v3
    s_lshl_b32 s52, s6, 3
    v_add_u32 v11, s52, v4
    v_lshl_add_u32 v11, v11, 5, s100
    v_mul_u32_u24 v11, 514, v11
    v_sub_u32 v12, s55, v11
    v_add_u32 v11, s54, v11
    v_cmp_lt_u32 vcc, s42, v10
    s_nop 1
    v_cndmask_b32 v11, v11, v12, vcc
    v_cndmask_b32 v185, 1, -1, vcc
    v_lshl_add_u32 v184, v10, 4, v11
    v_subrev_u32 v12, 1052672, v184
    v_min_u32 v186, v12, v184
    s_lshl_b32 s52, s6, 7
    s_lshl_b32 s53, s7, 6
    s_add_u32 s53, s53, s52
    s_add_u32 s53, s53, 81920
    v_lshl_add_u32 v176, v3, 2, s53
    v_lshl_add_u32 v177, v4, 4, s53
    v_xor_b32 v178, 64, v177
    s_lshl_b32 s52, s3, 12
    v_and_b32 v10, 1, v4
    v_bfe_u32 v11, v3, 1, 2
    v_xor_b32 v10, v10, v11
    v_lshlrev_b32 v10, 4, v10
    v_lshl_add_u32 v179, v3, 6, v10
    s_and_b32 s53, s6, 2
    s_lshl_b32 s53, s53, 6
    v_xor_b32 v179, s53, v179
    v_lshrrev_b32 v10, 1, v4
    v_lshl_add_u32 v179, v10, 11, v179
    v_add_u32 v179, s52, v179
    v_xor_b32 v182, 32, v179
    v_lshrrev_b32 v10, 2, v2
    v_and_b32 v10, 3, v10
    v_lshlrev_b32 v11, 6, v10
    v_and_b32 v11, 128, v11
    v_lshlrev_b32 v10, 12, v10
    v_lshl_add_u32 v10, v4, 6, v10
    v_xor_b32 v10, v10, v11
    v_lshrrev_b32 v11, 5, v2
    v_xor_b32 v11, v11, v2
    v_and_b32 v11, 3, v11
    v_lshl_add_u32 v10, v11, 4, v10
    s_lshl_b32 s52, s7, 14
    s_lshl_b32 s53, s6, 10
    s_add_u32 s52, s52, s53
    v_add_u32 v180, s52, v10
    v_xor_b32 v183, 32, v180
    v_lshlrev_b32 v181, 12, v4
    v_lshl_add_u32 v181, v3, 4, v181
    s_sub_u32 s55, s44, 11
    s_lshl_b32 s55, s55, 1
    s_add_u32 s55, s55, s7
    s_lshl_b32 s55, s55, 1
    s_lshr_b32 s52, s6, 1
    s_add_u32 s55, s55, s52
    s_lshl_b32 s52, s55, 17
    s_and_b32 s53, s6, 1
    s_lshl_b32 s53, s53, 16
    s_add_u32 s52, s52, s53
    s_lshl_b32 s53, s43, 8
    s_add_u32 s52, s52, s53
    s_add_u32 s52, s52, 6291456
    s_cmp_gt_u32 s55, 16
    s_cselect_b32 s0, 0x7f000000, s52
    s_waitcnt vmcnt(7)
    s_waitcnt lgkmcnt(0)
    s_barrier
    ds_read_b128 v[64:67], v200 offset:0
    ds_read_b128 v[72:75], v201 offset:0
    ds_read_b128 v[68:71], v202 offset:0
    ds_read_b128 v[76:79], v203 offset:0
    ds_read_b64_tr_b16 v[112:113], v192 offset:0
    ds_read_b64_tr_b16 v[114:115], v192 offset:2048
    ds_read_b64_tr_b16 v[116:117], v193 offset:0
    ds_read_b64_tr_b16 v[118:119], v193 offset:2048
    s_waitcnt vmcnt(5)
    s_barrier
    s_lshl_b32 s52, s50, 7
    s_add_u32 m0, s46, 98304
    s_nop 0
    buffer_load_dwordx4 v6, s[8:11], s52 offen lds
    s_add_u32 m0, s46, 99328
    s_nop 0
    buffer_load_dwordx4 v7, s[8:11], s52 offen lds
    s_add_u32 s50, s50, 1
    s_and_b32 s50, s50, 7
    s_waitcnt lgkmcnt(0)
    v_perm_b32 v96, v65, v64, s66
    v_perm_b32 v97, v67, v66, s66
    v_perm_b32 v98, v69, v68, s66
    v_perm_b32 v99, v71, v70, s66
    s_nop 1
    v_mfma_f32_16x16x32_bf16 v[128:131], v[96:99], v[112:115], 0
    v_perm_b32 v100, v65, v64, s67
    ds_read_b128 v[80:83], v200 offset:16384
    v_mfma_f32_16x16x32_bf16 v[136:139], v[96:99], v[116:119], 0
    v_perm_b32 v101, v67, v66, s67
    ds_read_b128 v[88:91], v201 offset:16384
    v_mfma_f32_16x16x32_bf16 v[40:43], v[56:59], v[96:99], 0
    v_perm_b32 v102, v69, v68, s67
    ds_read_b128 v[84:87], v202 offset:16384
    v_mfma_f32_16x16x32_bf16 v[44:47], v[96:99], v[96:99], 0
    v_perm_b32 v103, v71, v70, s67
    ds_read_b128 v[92:95], v203 offset:16384
    s_nop 0
    v_mfma_f32_16x16x32_bf16 v[144:147], v[100:103], v[112:115], 0
    v_perm_b32 v104, v73, v72, s66
    ds_read_b64_tr_b16 v[120:121], v192 offset:4096
    v_mfma_f32_16x16x32_bf16 v[152:155], v[100:103], v[116:119], 0
    v_perm_b32 v105, v75, v74, s66
    ds_read_b64_tr_b16 v[122:123], v192 offset:6144
    v_mfma_f32_16x16x32_bf16 v[40:43], v[56:59], v[100:103], v[40:43]
    v_perm_b32 v106, v77, v76, s66
    ds_read_b64_tr_b16 v[124:125], v193 offset:4096
    v_mfma_f32_16x16x32_bf16 v[44:47], v[100:103], v[100:103], v[44:47]
    v_perm_b32 v107, v79, v78, s66
    ds_read_b64_tr_b16 v[126:127], v193 offset:6144
    s_nop 0
    v_mfma_f32_16x16x32_bf16 v[132:135], v[104:107], v[112:115], 0
    v_perm_b32 v108, v73, v72, s67
    v_perm_b32 v109, v75, v74, s67
    v_mfma_f32_16x16x32_bf16 v[140:143], v[104:107], v[116:119], 0
    v_perm_b32 v110, v77, v76, s67
    v_perm_b32 v111, v79, v78, s67
    s_nop 1
    v_mfma_f32_16x16x32_bf16 v[148:151], v[108:111], v[112:115], 0
    v_mfma_f32_16x16x32_bf16 v[156:159], v[108:111], v[116:119], 0
    s_waitcnt vmcnt(5)
    s_barrier
    s_lshl_b32 s52, s50, 7
    s_add_u32 m0, s46, 114688
    s_nop 0
    buffer_load_dwordx4 v6, s[8:11], s52 offen lds
    s_add_u32 m0, s46, 115712
    s_nop 0
    buffer_load_dwordx4 v7, s[8:11], s52 offen lds
    s_add_u32 s50, s50, 1
    s_and_b32 s50, s50, 7
    s_waitcnt lgkmcnt(0)
    v_perm_b32 v96, v81, v80, s66
    v_perm_b32 v97, v83, v82, s66
    v_perm_b32 v98, v85, v84, s66
    v_perm_b32 v99, v87, v86, s66
    s_nop 1
    v_mfma_f32_16x16x32_bf16 v[128:131], v[96:99], v[120:123], v[128:131]
    v_perm_b32 v100, v81, v80, s67
    ds_read_b128 v[64:67], v200 offset:32768
    v_mfma_f32_16x16x32_bf16 v[136:139], v[96:99], v[124:127], v[136:139]
    v_perm_b32 v101, v83, v82, s67
    ds_read_b128 v[72:75], v201 offset:32768
    v_mfma_f32_16x16x32_bf16 v[40:43], v[56:59], v[96:99], v[40:43]
    v_perm_b32 v102, v85, v84, s67
    ds_read_b128 v[68:71], v202 offset:32768
    v_mfma_f32_16x16x32_bf16 v[44:47], v[96:99], v[96:99], v[44:47]
    v_perm_b32 v103, v87, v86, s67
    ds_read_b128 v[76:79], v203 offset:32768
    s_nop 0
    v_mfma_f32_16x16x32_bf16 v[144:147], v[100:103], v[120:123], v[144:147]
    v_perm_b32 v104, v89, v88, s66
    ds_read_b64_tr_b16 v[112:113], v192 offset:8192
    v_mfma_f32_16x16x32_bf16 v[152:155], v[100:103], v[124:127], v[152:155]
    v_perm_b32 v105, v91, v90, s66
    ds_read_b64_tr_b16 v[114:115], v192 offset:10240
    v_mfma_f32_16x16x32_bf16 v[40:43], v[56:59], v[100:103], v[40:43]
    v_perm_b32 v106, v93, v92, s66
    ds_read_b64_tr_b16 v[116:117], v193 offset:8192
    v_mfma_f32_16x16x32_bf16 v[44:47], v[100:103], v[100:103], v[44:47]
    v_perm_b32 v107, v95, v94, s66
    ds_read_b64_tr_b16 v[118:119], v193 offset:10240
    s_nop 0
    v_mfma_f32_16x16x32_bf16 v[132:135], v[104:107], v[120:123], v[132:135]
    v_perm_b32 v108, v89, v88, s67
    v_perm_b32 v109, v91, v90, s67
    v_mfma_f32_16x16x32_bf16 v[140:143], v[104:107], v[124:127], v[140:143]
    v_perm_b32 v110, v93, v92, s67
    v_perm_b32 v111, v95, v94, s67
    s_nop 1
    v_mfma_f32_16x16x32_bf16 v[148:151], v[108:111], v[120:123], v[148:151]
    v_mfma_f32_16x16x32_bf16 v[156:159], v[108:111], v[124:127], v[156:159]
    s_waitcnt vmcnt(5)
    s_barrier
    s_lshl_b32 s52, s50, 7
    s_add_u32 m0, s46, 131072
    s_nop 0
    buffer_load_dwordx4 v6, s[8:11], s52 offen lds
    s_add_u32 m0, s46, 132096
    s_nop 0
    buffer_load_dwordx4 v7, s[8:11], s52 offen lds
    s_add_u32 s50, s50, 1
    s_and_b32 s50, s50, 7
    s_waitcnt lgkmcnt(0)
    v_perm_b32 v96, v65, v64, s66
    v_perm_b32 v97, v67, v66, s66
    v_perm_b32 v98, v69, v68, s66
    v_perm_b32 v99, v71, v70, s66
    s_nop 1
    v_mfma_f32_16x16x32_bf16 v[128:131], v[96:99], v[112:115], v[128:131]
    v_perm_b32 v100, v65, v64, s67
    ds_read_b128 v[80:83], v200 offset:49152
    v_mfma_f32_16x16x32_bf16 v[136:139], v[96:99], v[116:119], v[136:139]
    v_perm_b32 v101, v67, v66, s67
    ds_read_b128 v[88:91], v201 offset:49152
    v_mfma_f32_16x16x32_bf16 v[40:43], v[56:59], v[96:99], v[40:43]
    v_perm_b32 v102, v69, v68, s67
    ds_read_b128 v[84:87], v202 offset:49152
    v_mfma_f32_16x16x32_bf16 v[44:47], v[96:99], v[96:99], v[44:47]
    v_perm_b32 v103, v71, v70, s67
    ds_read_b128 v[92:95], v203 offset:49152
    s_nop 0
    v_mfma_f32_16x16x32_bf16 v[144:147], v[100:103], v[112:115], v[144:147]
    v_perm_b32 v104, v73, v72, s66
    ds_read_b64_tr_b16 v[120:121], v192 offset:12288
    v_mfma_f32_16x16x32_bf16 v[152:155], v[100:103], v[116:119], v[152:155]
    v_perm_b32 v105, v75, v74, s66
    ds_read_b64_tr_b16 v[122:123], v192 offset:14336
    v_mfma_f32_16x16x32_bf16 v[40:43], v[56:59], v[100:103], v[40:43]
    v_perm_b32 v106, v77, v76, s66
    ds_read_b64_tr_b16 v[124:125], v193 offset:12288
    v_mfma_f32_16x16x32_bf16 v[44:47], v[100:103], v[100:103], v[44:47]
    v_perm_b32 v107, v79, v78, s66
    ds_read_b64_tr_b16 v[126:127], v193 offset:14336
    s_nop 0
    v_mfma_f32_16x16x32_bf16 v[132:135], v[104:107], v[112:115], v[132:135]
    v_perm_b32 v108, v73, v72, s67
    v_perm_b32 v109, v75, v74, s67
    v_mfma_f32_16x16x32_bf16 v[140:143], v[104:107], v[116:119], v[140:143]
    v_perm_b32 v110, v77, v76, s67
    v_perm_b32 v111, v79, v78, s67
    s_nop 1
    v_mfma_f32_16x16x32_bf16 v[148:151], v[108:111], v[112:115], v[148:151]
    v_mfma_f32_16x16x32_bf16 v[156:159], v[108:111], v[116:119], v[156:159]
    s_waitcnt vmcnt(4)
    s_barrier
    s_lshl_b32 s52, s50, 7
    s_add_u32 m0, s46, 147456
    s_nop 0
    buffer_load_dwordx4 v6, s[8:11], s52 offen lds
    s_add_u32 m0, s46, 148480
    s_nop 0
    buffer_load_dwordx4 v7, s[8:11], s52 offen lds
    s_add_u32 s50, s50, 1
    s_and_b32 s50, s50, 7
    s_waitcnt lgkmcnt(0)
    v_perm_b32 v96, v81, v80, s66
    v_perm_b32 v97, v83, v82, s66
    v_perm_b32 v98, v85, v84, s66
    v_perm_b32 v99, v87, v86, s66
    s_nop 1
    v_mfma_f32_16x16x32_bf16 v[128:131], v[96:99], v[120:123], v[128:131]
    v_perm_b32 v100, v81, v80, s67
    ds_read_b128 v[64:67], v204 offset:0
    v_mfma_f32_16x16x32_bf16 v[136:139], v[96:99], v[124:127], v[136:139]
    v_perm_b32 v101, v83, v82, s67
    ds_read_b128 v[72:75], v205 offset:0
    v_mfma_f32_16x16x32_bf16 v[40:43], v[56:59], v[96:99], v[40:43]
    v_perm_b32 v102, v85, v84, s67
    ds_read_b128 v[68:71], v206 offset:0
    v_mfma_f32_16x16x32_bf16 v[44:47], v[96:99], v[96:99], v[44:47]
    v_perm_b32 v103, v87, v86, s67
    ds_read_b128 v[76:79], v207 offset:0
    s_nop 0
    v_mfma_f32_16x16x32_bf16 v[144:147], v[100:103], v[120:123], v[144:147]
    v_perm_b32 v104, v89, v88, s66
    ds_read_b64_tr_b16 v[112:113], v194 offset:0
    v_mfma_f32_16x16x32_bf16 v[152:155], v[100:103], v[124:127], v[152:155]
    v_perm_b32 v105, v91, v90, s66
    ds_read_b64_tr_b16 v[114:115], v194 offset:2048
    v_mfma_f32_16x16x32_bf16 v[40:43], v[56:59], v[100:103], v[40:43]
    v_perm_b32 v106, v93, v92, s66
    ds_read_b64_tr_b16 v[116:117], v195 offset:0
    v_mfma_f32_16x16x32_bf16 v[44:47], v[100:103], v[100:103], v[44:47]
    v_perm_b32 v107, v95, v94, s66
    ds_read_b64_tr_b16 v[118:119], v195 offset:2048
    s_nop 0
    v_mfma_f32_16x16x32_bf16 v[132:135], v[104:107], v[120:123], v[132:135]
    v_perm_b32 v108, v89, v88, s67
    v_perm_b32 v109, v91, v90, s67
    v_mfma_f32_16x16x32_bf16 v[140:143], v[104:107], v[124:127], v[140:143]
    v_perm_b32 v110, v93, v92, s67
    v_perm_b32 v111, v95, v94, s67
    s_nop 1
    v_mfma_f32_16x16x32_bf16 v[148:151], v[108:111], v[120:123], v[148:151]
    v_mfma_f32_16x16x32_bf16 v[156:159], v[108:111], v[124:127], v[156:159]
    s_waitcnt vmcnt(4)
    s_barrier
    s_lshl_b32 s52, s7, 14
    s_lshl_b32 s53, s6, 11
    s_add_u32 s52, s52, s53
    s_add_u32 m0, s52, 32768
    s_nop 0
    buffer_load_dwordx4 v186, s[28:31], 0 offen lds
    s_mov_b32 s53, 65792
    v_mad_i32_i24 v187, v185, s53, v184
    s_add_u32 m0, s52, 33792
    s_nop 0
    buffer_load_dwordx4 v187, s[28:31], 0 offen lds
    s_waitcnt lgkmcnt(0)
    v_perm_b32 v96, v65, v64, s66
    v_perm_b32 v97, v67, v66, s66
    v_perm_b32 v98, v69, v68, s66
    v_perm_b32 v99, v71, v70, s66
    s_nop 1
    v_mfma_f32_16x16x32_bf16 v[128:131], v[96:99], v[112:115], v[128:131]
    v_perm_b32 v100, v65, v64, s67
    ds_read_b128 v[80:83], v204 offset:16384
    v_mfma_f32_16x16x32_bf16 v[136:139], v[96:99], v[116:119], v[136:139]
    v_perm_b32 v101, v67, v66, s67
    ds_read_b128 v[88:91], v205 offset:16384
    v_mfma_f32_16x16x32_bf16 v[40:43], v[56:59], v[96:99], v[40:43]
    v_perm_b32 v102, v69, v68, s67
    ds_read_b128 v[84:87], v206 offset:16384
    v_mfma_f32_16x16x32_bf16 v[44:47], v[96:99], v[96:99], v[44:47]
    v_perm_b32 v103, v71, v70, s67
    ds_read_b128 v[92:95], v207 offset:16384
    s_nop 0
    v_mfma_f32_16x16x32_bf16 v[144:147], v[100:103], v[112:115], v[144:147]
    v_perm_b32 v104, v73, v72, s66
    ds_read_b64_tr_b16 v[120:121], v194 offset:4096
    v_mfma_f32_16x16x32_bf16 v[152:155], v[100:103], v[116:119], v[152:155]
    v_perm_b32 v105, v75, v74, s66
    ds_read_b64_tr_b16 v[122:123], v194 offset:6144
    v_mfma_f32_16x16x32_bf16 v[40:43], v[56:59], v[100:103], v[40:43]
    v_perm_b32 v106, v77, v76, s66
    ds_read_b64_tr_b16 v[124:125], v195 offset:4096
    v_mfma_f32_16x16x32_bf16 v[44:47], v[100:103], v[100:103], v[44:47]
    v_perm_b32 v107, v79, v78, s66
    ds_read_b64_tr_b16 v[126:127], v195 offset:6144
    s_nop 0
    v_mfma_f32_16x16x32_bf16 v[132:135], v[104:107], v[112:115], v[132:135]
    v_perm_b32 v108, v73, v72, s67
    v_perm_b32 v109, v75, v74, s67
    v_mfma_f32_16x16x32_bf16 v[140:143], v[104:107], v[116:119], v[140:143]
    v_perm_b32 v110, v77, v76, s67
    v_perm_b32 v111, v79, v78, s67
    s_nop 1
    v_mfma_f32_16x16x32_bf16 v[148:151], v[108:111], v[112:115], v[148:151]
    v_mfma_f32_16x16x32_bf16 v[156:159], v[108:111], v[116:119], v[156:159]
    s_waitcnt vmcnt(4)
    s_barrier
    s_lshl_b32 s52, s7, 14
    s_lshl_b32 s53, s6, 11
    s_add_u32 s52, s52, s53
    s_mov_b32 s53, 526336
    v_mad_i32_i24 v188, v185, s53, v184
    s_add_u32 m0, s52, 40960
    s_nop 0
    buffer_load_dwordx4 v188, s[28:31], 0 offen lds
    s_mov_b32 s53, 592128
    v_mad_i32_i24 v189, v185, s53, v184
    s_add_u32 m0, s52, 41984
    s_nop 0
    buffer_load_dwordx4 v189, s[28:31], 0 offen lds
    s_waitcnt lgkmcnt(0)
    v_perm_b32 v96, v81, v80, s66
    v_perm_b32 v97, v83, v82, s66
    v_perm_b32 v98, v85, v84, s66
    v_perm_b32 v99, v87, v86, s66
    s_nop 1
    v_mfma_f32_16x16x32_bf16 v[128:131], v[96:99], v[120:123], v[128:131]
    v_perm_b32 v100, v81, v80, s67
    ds_read_b128 v[64:67], v204 offset:32768
    v_mfma_f32_16x16x32_bf16 v[136:139], v[96:99], v[124:127], v[136:139]
    v_perm_b32 v101, v83, v82, s67
    ds_read_b128 v[72:75], v205 offset:32768
    v_mfma_f32_16x16x32_bf16 v[40:43], v[56:59], v[96:99], v[40:43]
    v_perm_b32 v102, v85, v84, s67
    ds_read_b128 v[68:71], v206 offset:32768
    v_mfma_f32_16x16x32_bf16 v[44:47], v[96:99], v[96:99], v[44:47]
    v_perm_b32 v103, v87, v86, s67
    ds_read_b128 v[76:79], v207 offset:32768
    s_nop 0
    v_mfma_f32_16x16x32_bf16 v[144:147], v[100:103], v[120:123], v[144:147]
    v_perm_b32 v104, v89, v88, s66
    ds_read_b64_tr_b16 v[112:113], v194 offset:8192
    v_mfma_f32_16x16x32_bf16 v[152:155], v[100:103], v[124:127], v[152:155]
    v_perm_b32 v105, v91, v90, s66
    ds_read_b64_tr_b16 v[114:115], v194 offset:10240
    v_mfma_f32_16x16x32_bf16 v[40:43], v[56:59], v[100:103], v[40:43]
    v_perm_b32 v106, v93, v92, s66
    ds_read_b64_tr_b16 v[116:117], v195 offset:8192
    v_mfma_f32_16x16x32_bf16 v[44:47], v[100:103], v[100:103], v[44:47]
    v_perm_b32 v107, v95, v94, s66
    ds_read_b64_tr_b16 v[118:119], v195 offset:10240
    s_nop 0
    v_mfma_f32_16x16x32_bf16 v[132:135], v[104:107], v[120:123], v[132:135]
    v_perm_b32 v108, v89, v88, s67
    v_perm_b32 v109, v91, v90, s67
    v_mfma_f32_16x16x32_bf16 v[140:143], v[104:107], v[124:127], v[140:143]
    v_perm_b32 v110, v93, v92, s67
    v_perm_b32 v111, v95, v94, s67
    s_nop 1
    v_mfma_f32_16x16x32_bf16 v[148:151], v[108:111], v[120:123], v[148:151]
    v_mfma_f32_16x16x32_bf16 v[156:159], v[108:111], v[124:127], v[156:159]
    s_waitcnt vmcnt(4)
    s_barrier
    s_waitcnt lgkmcnt(0)
    v_perm_b32 v96, v65, v64, s66
    v_perm_b32 v97, v67, v66, s66
    v_perm_b32 v98, v69, v68, s66
    v_perm_b32 v99, v71, v70, s66
    s_nop 1
    v_mfma_f32_16x16x32_bf16 v[128:131], v[96:99], v[112:115], v[128:131]
    v_perm_b32 v100, v65, v64, s67
    ds_read_b128 v[80:83], v204 offset:49152
    v_mfma_f32_16x16x32_bf16 v[136:139], v[96:99], v[116:119], v[136:139]
    v_perm_b32 v101, v67, v66, s67
    ds_read_b128 v[88:91], v205 offset:49152
    v_mfma_f32_16x16x32_bf16 v[40:43], v[56:59], v[96:99], v[40:43]
    v_perm_b32 v102, v69, v68, s67
    ds_read_b128 v[84:87], v206 offset:49152
    v_mfma_f32_16x16x32_bf16 v[44:47], v[96:99], v[96:99], v[44:47]
    v_perm_b32 v103, v71, v70, s67
    ds_read_b128 v[92:95], v207 offset:49152
    s_nop 0
    v_mfma_f32_16x16x32_bf16 v[144:147], v[100:103], v[112:115], v[144:147]
    v_perm_b32 v104, v73, v72, s66
    ds_read_b64_tr_b16 v[120:121], v194 offset:12288
    v_mfma_f32_16x16x32_bf16 v[152:155], v[100:103], v[116:119], v[152:155]
    v_perm_b32 v105, v75, v74, s66
    ds_read_b64_tr_b16 v[122:123], v194 offset:14336
    v_mfma_f32_16x16x32_bf16 v[40:43], v[56:59], v[100:103], v[40:43]
    v_perm_b32 v106, v77, v76, s66
    ds_read_b64_tr_b16 v[124:125], v195 offset:12288
    v_mfma_f32_16x16x32_bf16 v[44:47], v[100:103], v[100:103], v[44:47]
    v_perm_b32 v107, v79, v78, s66
    ds_read_b64_tr_b16 v[126:127], v195 offset:14336
    s_nop 0
    v_mfma_f32_16x16x32_bf16 v[132:135], v[104:107], v[112:115], v[132:135]
    v_perm_b32 v108, v73, v72, s67
    v_perm_b32 v109, v75, v74, s67
    v_mfma_f32_16x16x32_bf16 v[140:143], v[104:107], v[116:119], v[140:143]
    v_perm_b32 v110, v77, v76, s67
    v_perm_b32 v111, v79, v78, s67
    s_nop 1
    v_mfma_f32_16x16x32_bf16 v[148:151], v[108:111], v[112:115], v[148:151]
    v_mfma_f32_16x16x32_bf16 v[156:159], v[108:111], v[116:119], v[156:159]
    s_waitcnt lgkmcnt(0)
    v_perm_b32 v96, v81, v80, s66
    v_perm_b32 v97, v83, v82, s66
    v_perm_b32 v98, v85, v84, s66
    v_perm_b32 v99, v87, v86, s66
    s_nop 1
    v_mfma_f32_16x16x32_bf16 v[128:131], v[96:99], v[120:123], v[128:131]
    v_perm_b32 v100, v81, v80, s67
    v_mfma_f32_16x16x32_bf16 v[136:139], v[96:99], v[124:127], v[136:139]
    v_perm_b32 v101, v83, v82, s67
    v_mfma_f32_16x16x32_bf16 v[40:43], v[56:59], v[96:99], v[40:43]
    v_perm_b32 v102, v85, v84, s67
    v_mfma_f32_16x16x32_bf16 v[44:47], v[96:99], v[96:99], v[44:47]
    v_perm_b32 v103, v87, v86, s67
    s_nop 1
    v_mfma_f32_16x16x32_bf16 v[144:147], v[100:103], v[120:123], v[144:147]
    v_perm_b32 v104, v89, v88, s66
    v_mfma_f32_16x16x32_bf16 v[152:155], v[100:103], v[124:127], v[152:155]
    v_perm_b32 v105, v91, v90, s66
    v_mfma_f32_16x16x32_bf16 v[40:43], v[56:59], v[100:103], v[40:43]
    v_perm_b32 v106, v93, v92, s66
    v_mfma_f32_16x16x32_bf16 v[44:47], v[100:103], v[100:103], v[44:47]
    v_perm_b32 v107, v95, v94, s66
    s_nop 1
    v_mfma_f32_16x16x32_bf16 v[132:135], v[104:107], v[120:123], v[132:135]
    v_perm_b32 v108, v89, v88, s67
    v_perm_b32 v109, v91, v90, s67
    v_mfma_f32_16x16x32_bf16 v[140:143], v[104:107], v[124:127], v[140:143]
    v_perm_b32 v110, v93, v92, s67
    v_perm_b32 v111, v95, v94, s67
    v_cndmask_b32 v17, v44, v45, s[58:59]
    v_cndmask_b32 v17, v17, v46, s[60:61]
    v_cndmask_b32 v17, v17, v47, s[62:63]
    v_mul_f32 v16, 0x3b000000, v40
    v_mul_f32 v17, 0x3b000000, v17
    v_fma_f32 v17, -v16, v16, v17
    v_max_f32 v17, 0, v17
    v_mfma_f32_16x16x32_bf16 v[148:151], v[108:111], v[120:123], v[148:151]
    v_cvt_pk_bf16_f32 v18, v16, v16
    v_lshlrev_b32 v16, 16, v18
    v_cvt_pk_bf16_f32 v18, v17, v17
    v_lshlrev_b32 v17, 16, v18
    v_add_f32 v17, 0x3727c5ac, v17
    v_cvt_pk_bf16_f32 v18, v17, v17
    v_lshlrev_b32 v17, 16, v18
    v_mfma_f32_16x16x32_bf16 v[156:159], v[108:111], v[124:127], v[156:159]
    v_sqrt_f32 v17, v17
    s_nop 0
    v_cvt_pk_bf16_f32 v18, v17, v17
    v_lshlrev_b32 v17, 16, v18
    v_rcp_f32 v17, v17
    s_mov_b64 exec, s[64:65]
    ds_write_b32 v176, v16
    ds_write_b32 v176, v17 offset:512
    s_mov_b64 exec, -1
    s_waitcnt lgkmcnt(0)
    s_barrier
    v_mov_b32 v9, 0
    v_mov_b32 v10, 149504
    ds_write_b32 v10, v9
    ds_write_b32 v10, v9 offset:4
    ds_write_b32 v10, v9 offset:8
    ds_write_b32 v10, v9 offset:12
    ds_write_b32 v10, v9 offset:16
    buffer_load_dword v246, v9, s[36:39], 0 offen sc1
    ds_read_b128 v[16:19], v177
    ds_read_b128 v[24:27], v177 offset:512
    ds_read_b128 v[20:23], v178
    ds_read_b128 v[28:31], v178 offset:512
    s_waitcnt lgkmcnt(0)
    s_add_u32 s52, s44, s7
    s_cmp_lg_u32 s52, 11
    s_cbranch_scc1 L_nomc
    v_mov_b32 v33, 0x43800000
    v_cndmask_b32 v32, 0, v33, s[56:57]
    v_mov_b32 v33, v32
    v_pk_fma_f32 v[144:145], v[16:17], v[32:33], v[144:145] neg_lo:[1,0,0] neg_hi:[1,0,0]
    v_pk_fma_f32 v[128:129], v[16:17], v[32:33], v[128:129] neg_lo:[1,0,0] neg_hi:[1,0,0]
    v_pk_fma_f32 v[146:147], v[18:19], v[32:33], v[146:147] neg_lo:[1,0,0] neg_hi:[1,0,0]
    v_pk_fma_f32 v[130:131], v[18:19], v[32:33], v[130:131] neg_lo:[1,0,0] neg_hi:[1,0,0]
    v_pk_fma_f32 v[148:149], v[20:21], v[32:33], v[148:149] neg_lo:[1,0,0] neg_hi:[1,0,0]
    v_pk_fma_f32 v[132:133], v[20:21], v[32:33], v[132:133] neg_lo:[1,0,0] neg_hi:[1,0,0]
    v_pk_fma_f32 v[150:151], v[22:23], v[32:33], v[150:151] neg_lo:[1,0,0] neg_hi:[1,0,0]
    v_pk_fma_f32 v[134:135], v[22:23], v[32:33], v[134:135] neg_lo:[1,0,0] neg_hi:[1,0,0]
L_nomc:
    v_pk_mul_f32 v[36:37], v[144:145], v[34:35]
    v_pk_mul_f32 v[38:39], v[152:153], v[34:35]
    v_pk_fma_f32 v[36:37], v[152:153], v[48:49], v[36:37]
    v_pk_fma_f32 v[38:39], v[144:145], v[48:49], v[38:39] neg_lo:[1,0,0] neg_hi:[1,0,0]
    v_pk_mul_f32 v[36:37], v[36:37], v[24:25]
    v_pk_mul_f32 v[38:39], v[38:39], v[24:25]
    v_pk_fma_f32 v[144:145], v[128:129], v[24:25], v[36:37]
    v_pk_fma_f32 v[152:153], v[136:137], v[24:25], v[38:39]
    v_pk_fma_f32 v[128:129], v[128:129], v[24:25], v[36:37] neg_lo:[0,0,1] neg_hi:[0,0,1]
    v_pk_fma_f32 v[136:137], v[136:137], v[24:25], v[38:39] neg_lo:[0,0,1] neg_hi:[0,0,1]
    v_pk_mul_f32 v[40:41], v[146:147], v[34:35]
    v_pk_mul_f32 v[42:43], v[154:155], v[34:35]
    v_pk_fma_f32 v[40:41], v[154:155], v[48:49], v[40:41]
    v_pk_fma_f32 v[42:43], v[146:147], v[48:49], v[42:43] neg_lo:[1,0,0] neg_hi:[1,0,0]
    v_pk_mul_f32 v[40:41], v[40:41], v[26:27]
    v_pk_mul_f32 v[42:43], v[42:43], v[26:27]
    v_pk_fma_f32 v[146:147], v[130:131], v[26:27], v[40:41]
    v_pk_fma_f32 v[154:155], v[138:139], v[26:27], v[42:43]
    v_pk_fma_f32 v[130:131], v[130:131], v[26:27], v[40:41] neg_lo:[0,0,1] neg_hi:[0,0,1]
    v_pk_fma_f32 v[138:139], v[138:139], v[26:27], v[42:43] neg_lo:[0,0,1] neg_hi:[0,0,1]
    v_pk_mul_f32 v[36:37], v[148:149], v[34:35]
    v_pk_mul_f32 v[38:39], v[156:157], v[34:35]
    v_pk_fma_f32 v[36:37], v[156:157], v[48:49], v[36:37]
    v_pk_fma_f32 v[38:39], v[148:149], v[48:49], v[38:39] neg_lo:[1,0,0] neg_hi:[1,0,0]
    v_pk_mul_f32 v[36:37], v[36:37], v[28:29]
    v_pk_mul_f32 v[38:39], v[38:39], v[28:29]
    v_pk_fma_f32 v[148:149], v[132:133], v[28:29], v[36:37]
    v_pk_fma_f32 v[156:157], v[140:141], v[28:29], v[38:39]
    v_pk_fma_f32 v[132:133], v[132:133], v[28:29], v[36:37] neg_lo:[0,0,1] neg_hi:[0,0,1]
    v_pk_fma_f32 v[140:141], v[140:141], v[28:29], v[38:39] neg_lo:[0,0,1] neg_hi:[0,0,1]
    v_pk_mul_f32 v[40:41], v[150:151], v[34:35]
    v_pk_mul_f32 v[42:43], v[158:159], v[34:35]
    v_pk_fma_f32 v[40:41], v[158:159], v[48:49], v[40:41]
    v_pk_fma_f32 v[42:43], v[150:151], v[48:49], v[42:43] neg_lo:[1,0,0] neg_hi:[1,0,0]
    v_pk_mul_f32 v[40:41], v[40:41], v[30:31]
    v_pk_mul_f32 v[42:43], v[42:43], v[30:31]
    v_pk_fma_f32 v[150:151], v[134:135], v[30:31], v[40:41]
    v_pk_fma_f32 v[158:159], v[142:143], v[30:31], v[42:43]
    v_pk_fma_f32 v[134:135], v[134:135], v[30:31], v[40:41] neg_lo:[0,0,1] neg_hi:[0,0,1]
    v_pk_fma_f32 v[142:143], v[142:143], v[30:31], v[42:43] neg_lo:[0,0,1] neg_hi:[0,0,1]
    v_cvt_pk_bf16_f32 v40, v144, v145
    v_cvt_pk_bf16_f32 v44, v152, v153
    v_cvt_pk_bf16_f32 v48, -v144, -v145
    v_cvt_pk_bf16_f32 v41, v146, v147
    v_cvt_pk_bf16_f32 v45, v154, v155
    v_cvt_pk_bf16_f32 v49, -v146, -v147
    v_cvt_pk_bf16_f32 v42, v148, v149
    v_cvt_pk_bf16_f32 v46, v156, v157
    v_cvt_pk_bf16_f32 v50, -v148, -v149
    v_cvt_pk_bf16_f32 v43, v150, v151
    v_cvt_pk_bf16_f32 v47, v158, v159
    v_cvt_pk_bf16_f32 v51, -v150, -v151
    v_mfma_f32_16x16x32_bf16 v[96:99], v[40:43], v[160:163], 0
    v_mfma_f32_16x16x32_bf16 v[100:103], v[44:47], v[160:163], 0
    v_mfma_f32_16x16x32_bf16 v[104:107], v[40:43], v[164:167], 0
    v_mfma_f32_16x16x32_bf16 v[108:111], v[44:47], v[164:167], 0
    v_mfma_f32_16x16x32_bf16 v[96:99], v[44:47], v[168:171], v[96:99]
    v_mfma_f32_16x16x32_bf16 v[100:103], v[48:51], v[168:171], v[100:103]
    v_mfma_f32_16x16x32_bf16 v[104:107], v[44:47], v[172:175], v[104:107]
    v_mfma_f32_16x16x32_bf16 v[108:111], v[48:51], v[172:175], v[108:111]
    v_cvt_pk_bf16_f32 v52, v128, v129
    v_cvt_pk_bf16_f32 v56, v136, v137
    v_cvt_pk_bf16_f32 v60, -v128, -v129
    v_cvt_pk_bf16_f32 v53, v130, v131
    v_cvt_pk_bf16_f32 v57, v138, v139
    v_cvt_pk_bf16_f32 v61, -v130, -v131
    v_cvt_pk_bf16_f32 v54, v132, v133
    v_cvt_pk_bf16_f32 v58, v140, v141
    v_cvt_pk_bf16_f32 v62, -v132, -v133
    v_cvt_pk_bf16_f32 v55, v134, v135
    v_cvt_pk_bf16_f32 v59, v142, v143
    v_cvt_pk_bf16_f32 v63, -v134, -v135
    v_mfma_f32_16x16x32_bf16 v[112:115], v[52:55], v[160:163], 0
    v_mfma_f32_16x16x32_bf16 v[116:119], v[56:59], v[160:163], 0
    v_mfma_f32_16x16x32_bf16 v[120:123], v[52:55], v[164:167], 0
    v_mfma_f32_16x16x32_bf16 v[124:127], v[56:59], v[164:167], 0
    v_mfma_f32_16x16x32_bf16 v[112:115], v[56:59], v[168:171], v[112:115]
    v_mfma_f32_16x16x32_bf16 v[116:119], v[60:63], v[168:171], v[116:119]
    v_mfma_f32_16x16x32_bf16 v[120:123], v[56:59], v[172:175], v[120:123]
    v_mfma_f32_16x16x32_bf16 v[124:127], v[60:63], v[172:175], v[124:127]
    v_cvt_pk_bf16_f32 v64, v96, v97
    v_cvt_pk_bf16_f32 v65, v98, v99
    v_cvt_pk_bf16_f32 v66, v100, v101
    v_cvt_pk_bf16_f32 v67, v102, v103
    ds_write_b128 v179, v[64:67] offset:0
    v_cvt_pk_bf16_f32 v68, v104, v105
    v_cvt_pk_bf16_f32 v69, v106, v107
    v_cvt_pk_bf16_f32 v70, v108, v109
    v_cvt_pk_bf16_f32 v71, v110, v111
    ds_write_b128 v179, v[68:71] offset:1024
    v_cvt_pk_bf16_f32 v72, v112, v113
    v_cvt_pk_bf16_f32 v73, v114, v115
    v_cvt_pk_bf16_f32 v74, v116, v117
    v_cvt_pk_bf16_f32 v75, v118, v119
    ds_write_b128 v182, v[72:75] offset:0
    v_cvt_pk_bf16_f32 v76, v120, v121
    v_cvt_pk_bf16_f32 v77, v122, v123
    v_cvt_pk_bf16_f32 v78, v124, v125
    v_cvt_pk_bf16_f32 v79, v126, v127
    ds_write_b128 v182, v[76:79] offset:1024
    s_waitcnt lgkmcnt(0)
    s_barrier
    ds_read_b128 v[80:83], v180 offset:0
    ds_read_b128 v[84:87], v183 offset:256
    ds_read_b128 v[88:91], v180 offset:512
    ds_read_b128 v[92:95], v183 offset:768
    s_waitcnt lgkmcnt(3)
    buffer_store_dwordx4 v[80:83], v181, s[20:23], s0 offen sc1
    s_add_u32 s0, s0, 16384
    s_waitcnt lgkmcnt(2)
    buffer_store_dwordx4 v[84:87], v181, s[20:23], s0 offen sc1
    s_add_u32 s0, s0, 16384
    s_waitcnt lgkmcnt(1)
    buffer_store_dwordx4 v[88:91], v181, s[20:23], s0 offen sc1
    s_add_u32 s0, s0, 16384
    s_waitcnt lgkmcnt(0)
    buffer_store_dwordx4 v[92:95], v181, s[20:23], s0 offen sc1
    s_waitcnt vmcnt(5)
    s_barrier
    v_mov_b32 v9, 0
    s_cmp_eq_u32 s3, 7
    s_nop 0
    s_cbranch_scc1 L_s7b
    s_cmp_ge_u32 s3, 6
    s_cbranch_scc1 L_noftS
    s_and_b32 s52, s3, 1
    s_lshl_b32 s52, s52, 4
    v_add_u32 v10, s52, v3
    s_lshr_b32 s52, s3, 1
    s_cmp_ge_u32 s52, 2
    s_cselect_b32 s53, 0, 1
    s_cselect_b32 s54, 3, 2
    s_cselect_b32 s55, 1, 0
    s_cmp_eq_u32 s52, 1
    s_cselect_b32 s52, 1, 0
    v_lshlrev_b32 v10, s53, v10
    v_add_u32 v10, s52, v10
    v_lshlrev_b32 v11, s54, v4
    v_add_u32 v11, s55, v11
    v_mul_u32_u24 v11, v10, v11
    v_and_b32 v11, 63, v11
    v_lshlrev_b32 v10, s55, v10
    v_cvt_f32_u32 v11, v11
    v_cvt_f32_u32 v10, v10
    v_mul_f32 v11, 0x3c800000, v11
    v_mul_f32 v10, 0x3c800000, v10
    v_cos_f32 v16, v11
    v_sin_f32 v24, v11
    v_fmamk_f32 v12, v10, 0x3f800000, v11
    v_fract_f32 v12, v12
    v_cos_f32 v17, v12
    v_sin_f32 v25, v12
    v_fmamk_f32 v12, v10, 0x40000000, v11
    v_fract_f32 v12, v12
    v_cos_f32 v18, v12
    v_sin_f32 v26, v12
    v_fmamk_f32 v12, v10, 0x40400000, v11
    v_fract_f32 v12, v12
    v_cos_f32 v19, v12
    v_sin_f32 v27, v12
    v_fmamk_f32 v12, v10, 0x41800000, v11
    v_fract_f32 v12, v12
    v_cos_f32 v20, v12
    v_sin_f32 v28, v12
    v_fmamk_f32 v12, v10, 0x41880000, v11
    v_fract_f32 v12, v12
    v_cos_f32 v21, v12
    v_sin_f32 v29, v12
    v_fmamk_f32 v12, v10, 0x41900000, v11
    v_fract_f32 v12, v12
    v_cos_f32 v22, v12
    v_sin_f32 v30, v12
    v_fmamk_f32 v12, v10, 0x41980000, v11
    v_fract_f32 v12, v12
    v_cos_f32 v23, v12
    v_sin_f32 v31, v12
    v_cvt_pk_bf16_f32 v184, v16, v17
    v_cvt_pk_bf16_f32 v188, v24, v25
    v_cvt_pk_bf16_f32 v185, v18, v19
    v_cvt_pk_bf16_f32 v189, v26, v27
    v_cvt_pk_bf16_f32 v186, v20, v21
    v_cvt_pk_bf16_f32 v190, v28, v29
    v_cvt_pk_bf16_f32 v187, v22, v23
    v_cvt_pk_bf16_f32 v191, v30, v31
    v_lshlrev_b32 v10, 4, v0
    v_add_u32 v10, 65536, v10
    ds_write_b128 v10, v[184:187]
    ds_write_b128 v10, v[188:191] offset:6144
    v_mov_b64 v[160:161], 0
    v_mov_b64 v[162:163], 0
    v_mov_b64 v[164:165], 0
    v_mov_b64 v[166:167], 0
    v_mov_b64 v[168:169], 0
    v_mov_b64 v[170:171], 0
    v_mov_b64 v[172:173], 0
    v_mov_b64 v[174:175], 0
    v_mov_b64 v[176:177], 0
    v_mov_b64 v[178:179], 0
    v_mov_b64 v[180:181], 0
    v_mov_b64 v[182:183], 0
    v_mov_b64 v[184:185], 0
    v_mov_b64 v[186:187], 0
    v_mov_b64 v[188:189], 0
    v_mov_b64 v[190:191], 0
    s_nop 1
L_noftS:
    s_lshl_b32 s68, s4, 2
    s_and_b32 s52, s5, 3
    s_add_u32 s68, s68, s52
    s_lshr_b32 s69, s5, 2
    s_lshl_b32 s70, s68, 1
    s_lshr_b32 s52, s6, 1
    s_add_u32 s70, s70, s52
    s_and_b32 s71, s6, 1
    s_mul_i32 s72, s70, 88
    s_lshl_b32 s52, s7, 1
    s_add_u32 s72, s72, s52
    s_add_u32 s72, s72, s71
    s_lshl_b32 s72, s72, 10
    s_lshl_b32 s73, s3, 11
    s_cmp_ge_u32 s3, 6
    s_cselect_b32 s77, 1277952, -1
    s_mul_i32 s74, s68, 69632
    s_add_u32 s74, s74, 9437184
    s_and_b32 s52, s5, 3
    s_mul_i32 s52, s52, 3
    s_add_u32 s75, s69, s4
    s_add_u32 s75, s75, s52
    s_cmp_ge_u32 s75, 11
    s_cselect_b32 s52, 11, 0
    s_sub_u32 s75, s75, s52
    s_cmp_ge_u32 s75, 11
    s_cselect_b32 s52, 11, 0
    s_sub_u32 s75, s75, s52
    v_lshrrev_b32 v10, 3, v2
    v_and_b32 v11, 7, v2
    v_and_b32 v12, 6, v10
    v_xor_b32 v11, v11, v12
    s_lshl_b32 s52, s3, 14
    s_lshl_b32 s53, s69, 7
    s_add_u32 s52, s52, s53
    v_lshlrev_b32 v10, 10, v10
    v_lshl_add_u32 v10, v11, 4, v10
    v_add_u32 v247, s52, v10
    s_mov_b32 s52, s75
    s_lshl_b32 s52, s52, 17
    s_min_u32 s52, s52, s77
    s_add_u32 m0, s73, 81920
    s_nop 0
    buffer_load_dwordx4 v247, s[16:19], s52 offen lds
    s_add_u32 s52, s52, 8192
    s_add_u32 m0, s73, 82944
    s_nop 0
    buffer_load_dwordx4 v247, s[16:19], s52 offen lds
    s_add_u32 s52, s75, 1
    s_cmp_ge_u32 s52, 11
    s_cselect_b32 s53, 11, 0
    s_sub_u32 s52, s52, s53
    s_lshl_b32 s52, s52, 17
    s_min_u32 s52, s52, s77
    s_add_u32 m0, s73, 98304
    s_nop 0
    buffer_load_dwordx4 v247, s[16:19], s52 offen lds
    s_add_u32 s52, s52, 8192
    s_add_u32 m0, s73, 99328
    s_nop 0
    buffer_load_dwordx4 v247, s[16:19], s52 offen lds
    s_waitcnt vmcnt(4) lgkmcnt(0)
    s_cmp_lg_u32 s3, 0
    s_cbranch_scc1 L_nopubS
    v_lshlrev_b32 v11, 11, v2
    v_mov_b32 v10, 1
    s_mov_b64 exec, 1
    s_nop 0
L_init_pollS:
    v_readfirstlane_b32 s52, v246
    s_nop 1
    s_cmp_lg_u32 s52, 0
    s_nop 1
    s_cbranch_scc1 L_init_okS
    buffer_load_dword v246, v9, s[36:39], 0 offen sc1
    s_waitcnt vmcnt(0)
    s_branch L_init_pollS
L_init_okS:
    s_sub_u32 s52, s44, 11
    s_lshl_b32 s52, s52, 8
    s_add_u32 s52, s52, 12632064
    s_mov_b32 exec_lo, -1
    s_barrier
    buffer_atomic_add v10, v11, s[20:23], s52 offen sc1
    s_mov_b64 exec, -1
    s_nop 0
    s_branch L_pubdS
L_nopubS:
    s_barrier
L_pubdS:
    s_cmp_eq_u32 s48, 0
    s_cbranch_scc1 L_nomidS
    v_add_u32 v12, 65536, v5
    ds_read_b128 v[64:67], v12 offset:0
    ds_read_b128 v[68:71], v12 offset:1024
    ds_read_b128 v[72:75], v12 offset:2048
    ds_read_b128 v[76:79], v12 offset:3072
    ds_read_b128 v[80:83], v12 offset:4096
    ds_read_b128 v[84:87], v12 offset:5120
    ds_read_b128 v[88:91], v12 offset:6144
    ds_read_b128 v[92:95], v12 offset:7168
    ds_read_b128 v[96:99], v12 offset:8192
    ds_read_b128 v[100:103], v12 offset:9216
    ds_read_b128 v[104:107], v12 offset:10240
    ds_read_b128 v[108:111], v12 offset:11264
    v_lshlrev_b32 v10, 1, v3
    v_add_u32 v11, s1, v10
    v_sub_u32 v10, s101, v10
    v_cmp_gt_u32 vcc, 8, v3
    s_nop 1
    v_cndmask_b32 v10, v10, v11, vcc
    v_cndmask_b32 v200, -1.0, 1.0, vcc
    v_and_b32 v201, 0x80000000, v200
    v_lshrrev_b32 v11, 4, v10
    v_lshlrev_b32 v12, 1, v4
    v_xor_b32 v11, v11, v12
    v_and_b32 v10, 15, v10
    v_lshl_add_u32 v10, v11, 4, v10
    v_lshl_add_u32 v10, v4, 11, v10
    v_add_u32 v10, 32768, v10
    ds_read_u16_d16_hi v160, v10 offset:0
    ds_read_u16_d16_hi v161, v10 offset:16384
    ds_read_u16_d16_hi v162, v10 offset:512
    ds_read_u16_d16_hi v163, v10 offset:16896
    ds_read_u16_d16_hi v164, v10 offset:1024
    ds_read_u16_d16_hi v165, v10 offset:17408
    ds_read_u16_d16_hi v166, v10 offset:1536
    ds_read_u16_d16_hi v167, v10 offset:17920
    ds_read_u16_d16_hi v168, v10 offset:8192
    ds_read_u16_d16_hi v169, v10 offset:24576
    ds_read_u16_d16_hi v170, v10 offset:8704
    ds_read_u16_d16_hi v171, v10 offset:25088
    ds_read_u16_d16_hi v172, v10 offset:9216
    ds_read_u16_d16_hi v173, v10 offset:25600
    ds_read_u16_d16_hi v174, v10 offset:9728
    ds_read_u16_d16_hi v175, v10 offset:26112
    ds_read_u16_d16_hi v176, v10 offset:256
    ds_read_u16_d16_hi v177, v10 offset:16640
    ds_read_u16_d16_hi v178, v10 offset:768
    ds_read_u16_d16_hi v179, v10 offset:17152
    ds_read_u16_d16_hi v180, v10 offset:1280
    ds_read_u16_d16_hi v181, v10 offset:17664
    ds_read_u16_d16_hi v182, v10 offset:1792
    ds_read_u16_d16_hi v183, v10 offset:18176
    ds_read_u16_d16_hi v184, v10 offset:8448
    ds_read_u16_d16_hi v185, v10 offset:24832
    ds_read_u16_d16_hi v186, v10 offset:8960
    ds_read_u16_d16_hi v187, v10 offset:25344
    ds_read_u16_d16_hi v188, v10 offset:9472
    ds_read_u16_d16_hi v189, v10 offset:25856
    ds_read_u16_d16_hi v190, v10 offset:9984
    ds_read_u16_d16_hi v191, v10 offset:26368
    s_waitcnt lgkmcnt(0)
    v_xor_b32 v161, v201, v161
    v_xor_b32 v163, v201, v163
    v_xor_b32 v165, v201, v165
    v_xor_b32 v167, v201, v167
    v_xor_b32 v169, v201, v169
    v_xor_b32 v171, v201, v171
    v_xor_b32 v173, v201, v173
    v_xor_b32 v175, v201, v175
    v_xor_b32 v177, v201, v177
    v_xor_b32 v179, v201, v179
    v_xor_b32 v181, v201, v181
    v_xor_b32 v183, v201, v183
    v_xor_b32 v185, v201, v185
    v_xor_b32 v187, v201, v187
    v_xor_b32 v189, v201, v189
    v_xor_b32 v191, v201, v191
    s_cmp_lg_u32 s47, 16
    s_nop 0
    s_cbranch_scc1 L_wnomaskS
    v_cmp_eq_u32 vcc, 0, v3
    s_nop 1
    v_cndmask_b32 v160, 0, v160, vcc
    v_cndmask_b32 v161, 0, v161, vcc
    v_cndmask_b32 v162, 0, v162, vcc
    v_cndmask_b32 v163, 0, v163, vcc
    v_cndmask_b32 v164, 0, v164, vcc
    v_cndmask_b32 v165, 0, v165, vcc
    v_cndmask_b32 v166, 0, v166, vcc
    v_cndmask_b32 v167, 0, v167, vcc
    v_cndmask_b32 v168, 0, v168, vcc
    v_cndmask_b32 v169, 0, v169, vcc
    v_cndmask_b32 v170, 0, v170, vcc
    v_cndmask_b32 v171, 0, v171, vcc
    v_cndmask_b32 v172, 0, v172, vcc
    v_cndmask_b32 v173, 0, v173, vcc
    v_cndmask_b32 v174, 0, v174, vcc
    v_cndmask_b32 v175, 0, v175, vcc
    v_cndmask_b32 v176, 0, v176, vcc
    v_cndmask_b32 v177, 0, v177, vcc
    v_cndmask_b32 v178, 0, v178, vcc
    v_cndmask_b32 v179, 0, v179, vcc
    v_cndmask_b32 v180, 0, v180, vcc
    v_cndmask_b32 v181, 0, v181, vcc
    v_cndmask_b32 v182, 0, v182, vcc
    v_cndmask_b32 v183, 0, v183, vcc
    v_cndmask_b32 v184, 0, v184, vcc
    v_cndmask_b32 v185, 0, v185, vcc
    v_cndmask_b32 v186, 0, v186, vcc
    v_cndmask_b32 v187, 0, v187, vcc
    v_cndmask_b32 v188, 0, v188, vcc
    v_cndmask_b32 v189, 0, v189, vcc
    v_cndmask_b32 v190, 0, v190, vcc
    v_cndmask_b32 v191, 0, v191, vcc
    s_nop 1
L_wnomaskS:
L_nomidS:
    s_barrier
    s_add_u32 s52, s75, 2
    s_cmp_ge_u32 s52, 11
    s_cselect_b32 s53, 11, 0
    s_sub_u32 s52, s52, s53
    s_lshl_b32 s52, s52, 17
    s_min_u32 s52, s52, s77
    s_add_u32 m0, s73, 114688
    s_nop 0
    buffer_load_dwordx4 v247, s[16:19], s52 offen lds
    s_add_u32 s52, s52, 8192
    s_add_u32 m0, s73, 115712
    s_nop 0
    buffer_load_dwordx4 v247, s[16:19], s52 offen lds
    s_add_u32 s52, s75, 3
    s_cmp_ge_u32 s52, 11
    s_cselect_b32 s53, 11, 0
    s_sub_u32 s52, s52, s53
    s_lshl_b32 s52, s52, 17
    s_min_u32 s52, s52, s77
    s_add_u32 m0, s73, 131072
    s_nop 0
    buffer_load_dwordx4 v247, s[16:19], s52 offen lds
    s_add_u32 s52, s52, 8192
    s_add_u32 m0, s73, 132096
    s_nop 0
    buffer_load_dwordx4 v247, s[16:19], s52 offen lds
    s_add_u32 s52, s75, 4
    s_cmp_ge_u32 s52, 11
    s_cselect_b32 s53, 11, 0
    s_sub_u32 s52, s52, s53
    s_lshl_b32 s52, s52, 17
    s_min_u32 s52, s52, s77
    s_add_u32 m0, s73, 16384
    s_nop 0
    buffer_load_dwordx4 v247, s[16:19], s52 offen lds
    s_add_u32 s52, s52, 8192
    s_add_u32 m0, s73, 17408
    s_nop 0
    buffer_load_dwordx4 v247, s[16:19], s52 offen lds
    s_lshl_b32 s52, s71, 20
    s_lshl_b32 s53, s70, 10
    s_add_u32 s52, s52, s53
    s_lshl_b32 s53, s69, 7
    s_add_u32 s52, s52, s53
    s_lshl_b32 s53, s7, 6
    s_add_u32 s52, s52, s53
    v_lshlrev_b32 v253, 16, v3
    v_lshl_add_u32 v253, v4, 3, v253
    v_add_u32 v253, s52, v253
    v_and_b32 v10, 1, v4
    v_mul_u32_u24 v10, 24, v10
    v_add_u32 v253, v10, v253
    buffer_load_dwordx4 v[232:235], v253, s[8:11], 0 offen
    v_lshrrev_b32 v10, 2, v3
    v_lshl_add_u32 v10, v4, 2, v10
    v_and_b32 v11, 6, v10
    v_and_b32 v12, 3, v2
    v_lshrrev_b32 v13, 1, v12
    v_xor_b32 v11, v11, v13
    v_and_b32 v12, 1, v12
    v_lshlrev_b32 v10, 7, v10
    v_lshl_add_u32 v10, v12, 3, v10
    s_lshl_b32 s52, s7, 13
    s_lshl_b32 s53, s71, 12
    s_add_u32 s52, s52, s53
    v_add_u32 v10, s52, v10
    s_mul_i32 s52, s71, 45056
    s_sub_u32 s53, 45056, s52
    v_add_u32 v248, s52, v5
    v_add_u32 v249, s53, v5
    s_lshl_b32 s52, s7, 2
    v_xor_b32 v11, s52, v11
    v_xor_b32 v12, 0, v11
    v_lshl_add_u32 v224, v12, 4, v10
    v_add_u32 v228, 0x10000, v224
    v_add_u32 v240, 0x20000, v224
    v_xor_b32 v12, 2, v11
    v_lshl_add_u32 v225, v12, 4, v10
    v_add_u32 v229, 0x10000, v225
    v_add_u32 v241, 0x20000, v225
    v_xor_b32 v12, 4, v11
    v_lshl_add_u32 v226, v12, 4, v10
    v_add_u32 v230, 0x10000, v226
    v_add_u32 v242, 0x20000, v226
    v_xor_b32 v12, 6, v11
    v_lshl_add_u32 v227, v12, 4, v10
    v_add_u32 v231, 0x10000, v227
    v_add_u32 v243, 0x20000, v227
    v_lshrrev_b32 v10, 3, v3
    v_and_b32 v11, 1, v4
    v_lshl_add_u32 v10, v10, 1, v11
    s_lshl_b32 s52, s71, 1
    v_xor_b32 v10, s52, v10
    v_lshlrev_b32 v10, 4, v10
    v_lshl_add_u32 v10, v3, 6, v10
    s_lshr_b32 s52, s6, 1
    s_lshl_b32 s52, s52, 11
    s_add_u32 s53, s52, 151552
    s_add_u32 s52, s52, 114688
    v_add_u32 v237, s53, v10
    v_lshrrev_b32 v11, 1, v4
    v_lshl_add_u32 v10, v11, 12, v10
    v_add_u32 v236, s52, v10
    v_subrev_u32 v238, 98304, v236
    v_lshl_add_u32 v10, v3, 6, s70
    v_lshlrev_b32 v11, 2, v4
    v_mul_u32_u24 v11, v10, v11
    v_and_b32 v11, 2047, v11
    v_cvt_f32_u32 v11, v11
    v_cvt_f32_u32 v10, v10
    v_mul_f32 v11, 0x3a000000, v11
    v_mul_f32 v10, 0x3a000000, v10
    v_cos_f32 v48, v11
    v_sin_f32 v56, v11
    v_fmamk_f32 v12, v10, 0x3f800000, v11
    v_fract_f32 v12, v12
    v_cos_f32 v49, v12
    v_sin_f32 v57, v12
    v_fmamk_f32 v12, v10, 0x40000000, v11
    v_fract_f32 v12, v12
    v_cos_f32 v50, v12
    v_sin_f32 v58, v12
    v_fmamk_f32 v12, v10, 0x40400000, v11
    v_fract_f32 v12, v12
    v_cos_f32 v51, v12
    v_sin_f32 v59, v12
    v_fmamk_f32 v12, v10, 0x41800000, v11
    v_fract_f32 v12, v12
    v_cos_f32 v52, v12
    v_sin_f32 v60, v12
    v_fmamk_f32 v12, v10, 0x41880000, v11
    v_fract_f32 v12, v12
    v_cos_f32 v53, v12
    v_sin_f32 v61, v12
    v_fmamk_f32 v12, v10, 0x41900000, v11
    v_fract_f32 v12, v12
    v_cos_f32 v54, v12
    v_sin_f32 v62, v12
    v_fmamk_f32 v12, v10, 0x41980000, v11
    v_fract_f32 v12, v12
    v_cos_f32 v55, v12
    v_sin_f32 v63, v12
    v_cvt_pk_bf16_f32 v208, v48, v49
    v_cvt_pk_bf16_f32 v212, -v56, -v57
    v_cvt_pk_bf16_f32 v209, v50, v51
    v_cvt_pk_bf16_f32 v213, -v58, -v59
    v_cvt_pk_bf16_f32 v210, v52, v53
    v_cvt_pk_bf16_f32 v214, -v60, -v61
    v_cvt_pk_bf16_f32 v211, v54, v55
    v_cvt_pk_bf16_f32 v215, -v62, -v63
    v_xor_b32 v216, 0x80000000, v208
    v_xor_b32 v217, 0x80000000, v209
    v_xor_b32 v218, 0x80000000, v210
    v_xor_b32 v219, 0x80000000, v211
    v_xor_b32 v220, 0x80000000, v212
    v_xor_b32 v221, 0x80000000, v213
    v_xor_b32 v222, 0x80000000, v214
    v_xor_b32 v223, 0x80000000, v215
    s_add_u32 s52, s75, 4
    s_cmp_ge_u32 s52, 11
    s_cselect_b32 s53, 11, 0
    s_sub_u32 s52, s52, s53
    s_lshl_b32 s52, s52, 12
    s_add_u32 s61, s52, s72
    s_add_u32 s53, s72, 45056
    s_add_u32 s52, s61, 4096
    s_cmp_eq_u32 s52, s53
    s_cselect_b32 s62, s72, s52
    s_add_u32 s52, s62, 4096
    s_cmp_eq_u32 s52, s53
    s_cselect_b32 s63, s72, s52
    s_add_u32 s52, s63, 4096
    s_cmp_eq_u32 s52, s53
    s_cselect_b32 s64, s72, s52
    s_add_u32 s52, s64, 4096
    s_cmp_eq_u32 s52, s53
    s_cselect_b32 s65, s72, s52
    s_add_u32 s52, s65, 4096
    s_cmp_eq_u32 s52, s53
    s_cselect_b32 s66, s72, s52
    s_add_u32 s52, s66, 4096
    s_cmp_eq_u32 s52, s53
    s_cselect_b32 s67, s72, s52
    s_sub_u32 s52, s65, s72
    s_lshl_b32 s52, s52, 5
    s_min_u32 s45, s52, s77
    s_sub_u32 s52, s66, s72
    s_lshl_b32 s52, s52, 5
    s_min_u32 s46, s52, s77
    s_sub_u32 s52, s67, s72
    s_lshl_b32 s52, s52, 5
    s_min_u32 s50, s52, s77
    s_cmp_lg_u32 s48, 0
    s_cbranch_scc1 L_sact
    s_add_u32 s52, s75, 5
    s_cmp_ge_u32 s52, 11
    s_cselect_b32 s53, 11, 0
    s_sub_u32 s52, s52, s53
    s_lshl_b32 s52, s52, 17
    s_min_u32 s52, s52, s77
    s_add_u32 m0, s73, 32768
    s_nop 0
    buffer_load_dwordx4 v247, s[16:19], s52 offen lds
    s_add_u32 s52, s52, 8192
    s_add_u32 m0, s73, 33792
    s_nop 0
    buffer_load_dwordx4 v247, s[16:19], s52 offen lds
    s_add_u32 s52, s75, 6
    s_cmp_ge_u32 s52, 11
    s_cselect_b32 s53, 11, 0
    s_sub_u32 s52, s52, s53
    s_lshl_b32 s52, s52, 17
    s_min_u32 s52, s52, s77
    s_add_u32 m0, s73, 49152
    s_nop 0
    buffer_load_dwordx4 v247, s[16:19], s52 offen lds
    s_add_u32 s52, s52, 8192
    s_add_u32 m0, s73, 50176
    s_nop 0
    buffer_load_dwordx4 v247, s[16:19], s52 offen lds
    s_add_u32 s52, s75, 7
    s_cmp_ge_u32 s52, 11
    s_cselect_b32 s53, 11, 0
    s_sub_u32 s52, s52, s53
    s_lshl_b32 s52, s52, 17
    s_min_u32 s52, s52, s77
    s_add_u32 m0, s73, 65536
    s_nop 0
    buffer_load_dwordx4 v247, s[16:19], s52 offen lds
    s_add_u32 s52, s52, 8192
    s_add_u32 m0, s73, 66560
    s_nop 0
    buffer_load_dwordx4 v247, s[16:19], s52 offen lds
    s_branch L_gg0
L_sact:
    s_setprio 3
    s_lshl_b32 s55, s68, 11
    s_add_u32 s55, s55, 12632064
    s_lshr_b32 s52, s47, 2
    s_lshl_b32 s52, s52, 8
    s_add_u32 s55, s55, s52
    s_buffer_load_dword s56, s[20:23], s55 glc
    v_lshrrev_b32 v13, 2, v3
    v_lshl_add_u32 v13, v4, 2, v13
    v_lshlrev_b32 v13, 6, v13
    v_and_b32 v11, 3, v2
    v_lshl_add_u32 v13, v11, 4, v13
    v_add_u32 v13, s49, v13
    v_bfe_u32 v14, v3, 1, 2
    v_xor_b32 v14, v14, v4
    v_lshlrev_b32 v14, 4, v14
    v_lshl_add_u32 v14, v3, 6, v14
    v_add_u32 v14, s49, v14
    v_add_u32 v12, s49, v5
    s_lshl_b32 s52, s47, 12
    s_lshl_b32 s53, s100, 6
    s_add_u32 s52, s52, s53
    s_add_u32 s41, s52, 9437184
    s_mov_b32 s53, 69632
    v_lshrrev_b32 v15, 3, v2
    v_mul_lo_u32 v15, v15, s53
    v_and_b32 v11, 4, v2
    v_lshl_add_u32 v15, v11, 9, v15
    s_lshr_b32 s52, s100, 2
    s_and_b32 s52, s52, 2
    v_lshrrev_b32 v11, 3, v2
    v_xor_b32 v11, v11, v2
    v_xor_b32 v11, s52, v11
    v_and_b32 v11, 3, v11
    v_lshl_add_u32 v15, v11, 4, v15
    s_waitcnt lgkmcnt(0)
    s_cmp_ge_u32 s56, 16
    s_cbranch_scc1 L_sdp_ok
L_sdp:
    s_buffer_load_dword s56, s[20:23], s55 glc
    s_waitcnt lgkmcnt(0)
    s_cmp_lt_u32 s56, 16
    s_cbranch_scc1 L_sdp
L_sdp_ok:
    s_lshl_b32 s52, s51, 12
    s_add_u32 s52, s52, 6291456
    s_mov_b32 m0, s49
    s_nop 0
    buffer_load_dwordx4 v5, s[20:23], s52 offen offset:0 sc1 lds
    buffer_load_dwordx4 v5, s[20:23], s52 offen offset:1024 sc1 lds
    buffer_load_dwordx4 v5, s[20:23], s52 offen offset:2048 sc1 lds
    buffer_load_dwordx4 v5, s[20:23], s52 offen offset:3072 sc1 lds
    s_add_u32 s52, s75, 5
    s_cmp_ge_u32 s52, 11
    s_cselect_b32 s53, 11, 0
    s_sub_u32 s52, s52, s53
    s_lshl_b32 s52, s52, 17
    s_min_u32 s52, s52, s77
    s_add_u32 m0, s73, 32768
    s_nop 0
    buffer_load_dwordx4 v247, s[16:19], s52 offen lds
    s_add_u32 s52, s52, 8192
    s_add_u32 m0, s73, 33792
    s_nop 0
    buffer_load_dwordx4 v247, s[16:19], s52 offen lds
    s_add_u32 s52, s75, 6
    s_cmp_ge_u32 s52, 11
    s_cselect_b32 s53, 11, 0
    s_sub_u32 s52, s52, s53
    s_lshl_b32 s52, s52, 17
    s_min_u32 s52, s52, s77
    s_add_u32 m0, s73, 49152
    s_nop 0
    buffer_load_dwordx4 v247, s[16:19], s52 offen lds
    s_add_u32 s52, s52, 8192
    s_add_u32 m0, s73, 50176
    s_nop 0
    buffer_load_dwordx4 v247, s[16:19], s52 offen lds
    s_add_u32 s52, s75, 7
    s_cmp_ge_u32 s52, 11
    s_cselect_b32 s53, 11, 0
    s_sub_u32 s52, s52, s53
    s_lshl_b32 s52, s52, 17
    s_min_u32 s52, s52, s77
    s_add_u32 m0, s73, 65536
    s_nop 0
    buffer_load_dwordx4 v247, s[16:19], s52 offen lds
    s_add_u32 s52, s52, 8192
    s_add_u32 m0, s73, 66560
    s_nop 0
    buffer_load_dwordx4 v247, s[16:19], s52 offen lds
    s_waitcnt vmcnt(6)
L_p2:
    s_waitcnt lgkmcnt(0)
    ds_read_b64_tr_b16 v[16:17], v13 offset:0
    ds_read_b64_tr_b16 v[24:25], v13 offset:8
    ds_read_b64_tr_b16 v[18:19], v13 offset:1024
    ds_read_b64_tr_b16 v[26:27], v13 offset:1032
    ds_read_b64_tr_b16 v[20:21], v13 offset:2048
    ds_read_b64_tr_b16 v[28:29], v13 offset:2056
    ds_read_b64_tr_b16 v[22:23], v13 offset:3072
    ds_read_b64_tr_b16 v[30:31], v13 offset:3080
    s_waitcnt lgkmcnt(4)
    v_xor_b32 v32, 0x80008000, v16
    v_xor_b32 v33, 0x80008000, v17
    v_xor_b32 v34, 0x80008000, v18
    v_xor_b32 v35, 0x80008000, v19
    v_mfma_f32_16x16x32_bf16 v[128:131], v[64:67], v[16:19], 0
    v_mfma_f32_16x16x32_bf16 v[132:135], v[68:71], v[16:19], 0
    v_mfma_f32_16x16x32_bf16 v[144:147], v[64:67], v[24:27], 0
    v_mfma_f32_16x16x32_bf16 v[148:151], v[68:71], v[24:27], 0
    s_waitcnt lgkmcnt(0)
    v_mfma_f32_16x16x32_bf16 v[128:131], v[88:91], v[24:27], v[128:131]
    v_xor_b32 v36, 0x80008000, v20
    v_xor_b32 v37, 0x80008000, v21
    v_mfma_f32_16x16x32_bf16 v[132:135], v[92:95], v[24:27], v[132:135]
    v_xor_b32 v38, 0x80008000, v22
    v_xor_b32 v39, 0x80008000, v23
    v_mfma_f32_16x16x32_bf16 v[144:147], v[88:91], v[32:35], v[144:147]
    v_xor_b32 v40, 0x80008000, v28
    v_xor_b32 v41, 0x80008000, v29
    v_mfma_f32_16x16x32_bf16 v[148:151], v[92:95], v[32:35], v[148:151]
    v_xor_b32 v42, 0x80008000, v30
    v_xor_b32 v43, 0x80008000, v31
    v_mfma_f32_16x16x32_bf16 v[128:131], v[64:67], v[20:23], v[128:131]
    v_mfma_f32_16x16x32_bf16 v[132:135], v[68:71], v[20:23], v[132:135]
    v_mfma_f32_16x16x32_bf16 v[144:147], v[64:67], v[28:31], v[144:147]
    v_mfma_f32_16x16x32_bf16 v[148:151], v[68:71], v[28:31], v[148:151]
    v_mfma_f32_16x16x32_bf16 v[128:131], v[88:91], v[28:31], v[128:131]
    v_mfma_f32_16x16x32_bf16 v[132:135], v[92:95], v[28:31], v[132:135]
    v_mfma_f32_16x16x32_bf16 v[144:147], v[88:91], v[36:39], v[144:147]
    v_mfma_f32_16x16x32_bf16 v[148:151], v[92:95], v[36:39], v[148:151]
    v_mfma_f32_16x16x32_bf16 v[136:139], v[72:75], v[16:19], 0
    v_mfma_f32_16x16x32_bf16 v[140:143], v[76:79], v[16:19], 0
    v_mfma_f32_16x16x32_bf16 v[152:155], v[72:75], v[24:27], 0
    v_mfma_f32_16x16x32_bf16 v[156:159], v[76:79], v[24:27], 0
    v_mfma_f32_16x16x32_bf16 v[136:139], v[96:99], v[24:27], v[136:139]
    v_mul_f32 v192, v128, v160
    v_mul_f32 v196, v128, v161
    v_mul_f32 v193, v129, v162
    v_mul_f32 v197, v129, v163
    v_mul_f32 v194, v130, v164
    v_mfma_f32_16x16x32_bf16 v[140:143], v[100:103], v[24:27], v[140:143]
    v_mul_f32 v198, v130, v165
    v_mul_f32 v195, v131, v166
    v_mul_f32 v199, v131, v167
    v_fma_f32 v192, -v144, v161, v192
    v_fmac_f32 v196, v144, v160
    v_mfma_f32_16x16x32_bf16 v[152:155], v[96:99], v[32:35], v[152:155]
    v_fma_f32 v193, -v145, v163, v193
    v_fmac_f32 v197, v145, v162
    v_fma_f32 v194, -v146, v165, v194
    v_fmac_f32 v198, v146, v164
    v_fma_f32 v195, -v147, v167, v195
    v_mfma_f32_16x16x32_bf16 v[156:159], v[100:103], v[32:35], v[156:159]
    v_fmac_f32 v199, v147, v166
    v_fmac_f32_dpp v192, v192, v200 row_ror:8 row_mask:0xf bank_mask:0xf
    v_fmac_f32_dpp v196, v196, v200 row_ror:8 row_mask:0xf bank_mask:0xf
    v_fmac_f32_dpp v193, v193, v200 row_ror:8 row_mask:0xf bank_mask:0xf
    v_fmac_f32_dpp v197, v197, v200 row_ror:8 row_mask:0xf bank_mask:0xf
    v_mfma_f32_16x16x32_bf16 v[136:139], v[72:75], v[36:39], v[136:139]
    v_fmac_f32_dpp v194, v194, v200 row_ror:8 row_mask:0xf bank_mask:0xf
    v_fmac_f32_dpp v198, v198, v200 row_ror:8 row_mask:0xf bank_mask:0xf
    v_fmac_f32_dpp v195, v195, v200 row_ror:8 row_mask:0xf bank_mask:0xf
    v_fmac_f32_dpp v199, v199, v200 row_ror:8 row_mask:0xf bank_mask:0xf
    v_cvt_pk_bf16_f32 v44, v192, v193
    v_mfma_f32_16x16x32_bf16 v[140:143], v[76:79], v[36:39], v[140:143]
    v_cvt_pk_bf16_f32 v52, v196, v197
    v_cvt_pk_bf16_f32 v112, -v196, -v197
    v_cvt_pk_bf16_f32 v45, v194, v195
    v_cvt_pk_bf16_f32 v53, v198, v199
    v_cvt_pk_bf16_f32 v113, -v198, -v199
    v_mfma_f32_16x16x32_bf16 v[152:155], v[72:75], v[40:43], v[152:155]
    v_mul_f32 v192, v132, v168
    v_mul_f32 v196, v132, v169
    v_mul_f32 v193, v133, v170
    v_mul_f32 v197, v133, v171
    v_mul_f32 v194, v134, v172
    v_mfma_f32_16x16x32_bf16 v[156:159], v[76:79], v[40:43], v[156:159]
    v_mul_f32 v198, v134, v173
    v_mul_f32 v195, v135, v174
    v_mul_f32 v199, v135, v175
    v_fma_f32 v192, -v148, v169, v192
    v_fmac_f32 v196, v148, v168
    v_mfma_f32_16x16x32_bf16 v[136:139], v[96:99], v[40:43], v[136:139]
    v_fma_f32 v193, -v149, v171, v193
    v_fmac_f32 v197, v149, v170
    v_fma_f32 v194, -v150, v173, v194
    v_fmac_f32 v198, v150, v172
    v_fma_f32 v195, -v151, v175, v195
    v_mfma_f32_16x16x32_bf16 v[140:143], v[100:103], v[40:43], v[140:143]
    v_fmac_f32 v199, v151, v174
    v_fmac_f32_dpp v192, v192, v200 row_ror:8 row_mask:0xf bank_mask:0xf
    v_fmac_f32_dpp v196, v196, v200 row_ror:8 row_mask:0xf bank_mask:0xf
    v_fmac_f32_dpp v193, v193, v200 row_ror:8 row_mask:0xf bank_mask:0xf
    v_fmac_f32_dpp v197, v197, v200 row_ror:8 row_mask:0xf bank_mask:0xf
    v_mfma_f32_16x16x32_bf16 v[152:155], v[96:99], v[20:23], v[152:155]
    v_fmac_f32_dpp v194, v194, v200 row_ror:8 row_mask:0xf bank_mask:0xf
    v_fmac_f32_dpp v198, v198, v200 row_ror:8 row_mask:0xf bank_mask:0xf
    v_fmac_f32_dpp v195, v195, v200 row_ror:8 row_mask:0xf bank_mask:0xf
    v_fmac_f32_dpp v199, v199, v200 row_ror:8 row_mask:0xf bank_mask:0xf
    v_cvt_pk_bf16_f32 v46, v192, v193
    v_mfma_f32_16x16x32_bf16 v[156:159], v[100:103], v[20:23], v[156:159]
    v_cvt_pk_bf16_f32 v54, v196, v197
    v_cvt_pk_bf16_f32 v114, -v196, -v197
    v_cvt_pk_bf16_f32 v47, v194, v195
    v_cvt_pk_bf16_f32 v55, v198, v199
    v_cvt_pk_bf16_f32 v115, -v198, -v199
    v_mfma_f32_16x16x32_bf16 v[16:19], v[44:47], v[64:67], 0
    v_mul_f32 v192, v136, v176
    v_mul_f32 v196, v136, v177
    v_mul_f32 v193, v137, v178
    v_mul_f32 v197, v137, v179
    v_mul_f32 v194, v138, v180
    v_mul_f32 v198, v138, v181
    v_mul_f32 v195, v139, v182
    v_mfma_f32_16x16x32_bf16 v[24:27], v[52:55], v[64:67], 0
    v_mul_f32 v199, v139, v183
    v_fma_f32 v192, -v152, v177, v192
    v_fmac_f32 v196, v152, v176
    v_fma_f32 v193, -v153, v179, v193
    v_fmac_f32 v197, v153, v178
    v_fma_f32 v194, -v154, v181, v194
    v_fmac_f32 v198, v154, v180
    v_fma_f32 v195, -v155, v183, v195
    v_mfma_f32_16x16x32_bf16 v[20:23], v[44:47], v[68:71], 0
    v_fmac_f32 v199, v155, v182
    v_fmac_f32_dpp v192, v192, v200 row_ror:8 row_mask:0xf bank_mask:0xf
    v_fmac_f32_dpp v196, v196, v200 row_ror:8 row_mask:0xf bank_mask:0xf
    v_fmac_f32_dpp v193, v193, v200 row_ror:8 row_mask:0xf bank_mask:0xf
    v_fmac_f32_dpp v197, v197, v200 row_ror:8 row_mask:0xf bank_mask:0xf
    v_fmac_f32_dpp v194, v194, v200 row_ror:8 row_mask:0xf bank_mask:0xf
    v_fmac_f32_dpp v198, v198, v200 row_ror:8 row_mask:0xf bank_mask:0xf
    v_mfma_f32_16x16x32_bf16 v[28:31], v[52:55], v[68:71], 0
    v_fmac_f32_dpp v195, v195, v200 row_ror:8 row_mask:0xf bank_mask:0xf
    v_fmac_f32_dpp v199, v199, v200 row_ror:8 row_mask:0xf bank_mask:0xf
    v_cvt_pk_bf16_f32 v48, v192, v193
    v_cvt_pk_bf16_f32 v56, v196, v197
    v_cvt_pk_bf16_f32 v116, -v196, -v197
    v_cvt_pk_bf16_f32 v49, v194, v195
    v_cvt_pk_bf16_f32 v57, v198, v199
    v_cvt_pk_bf16_f32 v117, -v198, -v199
    v_mfma_f32_16x16x32_bf16 v[16:19], v[112:115], v[88:91], v[16:19]
    v_mul_f32 v192, v140, v184
    v_mul_f32 v196, v140, v185
    v_mul_f32 v193, v141, v186
    v_mul_f32 v197, v141, v187
    v_mul_f32 v194, v142, v188
    v_mul_f32 v198, v142, v189
    v_mul_f32 v195, v143, v190
    v_mfma_f32_16x16x32_bf16 v[24:27], v[44:47], v[88:91], v[24:27]
    v_mul_f32 v199, v143, v191
    v_fma_f32 v192, -v156, v185, v192
    v_fmac_f32 v196, v156, v184
    v_fma_f32 v193, -v157, v187, v193
    v_fmac_f32 v197, v157, v186
    v_fma_f32 v194, -v158, v189, v194
    v_fmac_f32 v198, v158, v188
    v_fma_f32 v195, -v159, v191, v195
    v_mfma_f32_16x16x32_bf16 v[20:23], v[112:115], v[92:95], v[20:23]
    v_fmac_f32 v199, v159, v190
    v_fmac_f32_dpp v192, v192, v200 row_ror:8 row_mask:0xf bank_mask:0xf
    v_fmac_f32_dpp v196, v196, v200 row_ror:8 row_mask:0xf bank_mask:0xf
    v_fmac_f32_dpp v193, v193, v200 row_ror:8 row_mask:0xf bank_mask:0xf
    v_fmac_f32_dpp v197, v197, v200 row_ror:8 row_mask:0xf bank_mask:0xf
    v_fmac_f32_dpp v194, v194, v200 row_ror:8 row_mask:0xf bank_mask:0xf
    v_fmac_f32_dpp v198, v198, v200 row_ror:8 row_mask:0xf bank_mask:0xf
    v_mfma_f32_16x16x32_bf16 v[28:31], v[44:47], v[92:95], v[28:31]
    v_fmac_f32_dpp v195, v195, v200 row_ror:8 row_mask:0xf bank_mask:0xf
    v_fmac_f32_dpp v199, v199, v200 row_ror:8 row_mask:0xf bank_mask:0xf
    v_cvt_pk_bf16_f32 v50, v192, v193
    v_cvt_pk_bf16_f32 v58, v196, v197
    v_cvt_pk_bf16_f32 v118, -v196, -v197
    v_cvt_pk_bf16_f32 v51, v194, v195
    v_cvt_pk_bf16_f32 v59, v198, v199
    v_cvt_pk_bf16_f32 v119, -v198, -v199
    v_mfma_f32_16x16x32_bf16 v[128:131], v[48:51], v[80:83], 0
    v_mfma_f32_16x16x32_bf16 v[144:147], v[56:59], v[80:83], 0
    v_mfma_f32_16x16x32_bf16 v[132:135], v[48:51], v[84:87], 0
    v_mfma_f32_16x16x32_bf16 v[148:151], v[56:59], v[84:87], 0
    v_mfma_f32_16x16x32_bf16 v[128:131], v[116:119], v[104:107], v[128:131]
    v_mfma_f32_16x16x32_bf16 v[144:147], v[48:51], v[104:107], v[144:147]
    v_mfma_f32_16x16x32_bf16 v[132:135], v[116:119], v[108:111], v[132:135]
    v_mfma_f32_16x16x32_bf16 v[148:151], v[48:51], v[108:111], v[148:151]
    s_nop 4
    v_add_f32 v32, v16, v128
    v_sub_f32 v128, v16, v128
    v_add_f32 v33, v17, v129
    v_sub_f32 v129, v17, v129
    v_add_f32 v34, v18, v130
    v_sub_f32 v130, v18, v130
    v_add_f32 v35, v19, v131
    v_sub_f32 v131, v19, v131
    v_add_f32 v36, v24, v144
    v_sub_f32 v144, v24, v144
    v_add_f32 v37, v25, v145
    v_sub_f32 v145, v25, v145
    v_add_f32 v38, v26, v146
    v_sub_f32 v146, v26, v146
    v_add_f32 v39, v27, v147
    v_sub_f32 v147, v27, v147
    v_cvt_pk_bf16_f32 v44, v32, v33
    v_cvt_pk_bf16_f32 v46, v36, v37
    v_cvt_pk_bf16_f32 v45, v34, v35
    v_cvt_pk_bf16_f32 v47, v38, v39
    ds_write_b128 v14, v[44:47] offset:0
    v_cvt_pk_bf16_f32 v48, v128, v129
    v_cvt_pk_bf16_f32 v50, v144, v145
    v_cvt_pk_bf16_f32 v49, v130, v131
    v_cvt_pk_bf16_f32 v51, v146, v147
    ds_write_b128 v14, v[48:51] offset:2048
    v_add_f32 v32, v20, v132
    v_sub_f32 v132, v20, v132
    v_add_f32 v33, v21, v133
    v_sub_f32 v133, v21, v133
    v_add_f32 v34, v22, v134
    v_sub_f32 v134, v22, v134
    v_add_f32 v35, v23, v135
    v_sub_f32 v135, v23, v135
    v_add_f32 v36, v28, v148
    v_sub_f32 v148, v28, v148
    v_add_f32 v37, v29, v149
    v_sub_f32 v149, v29, v149
    v_add_f32 v38, v30, v150
    v_sub_f32 v150, v30, v150
    v_add_f32 v39, v31, v151
    v_sub_f32 v151, v31, v151
    v_cvt_pk_bf16_f32 v52, v32, v33
    v_cvt_pk_bf16_f32 v54, v36, v37
    v_cvt_pk_bf16_f32 v53, v34, v35
    v_cvt_pk_bf16_f32 v55, v38, v39
    ds_write_b128 v14, v[52:55] offset:1024
    v_cvt_pk_bf16_f32 v56, v132, v133
    v_cvt_pk_bf16_f32 v58, v148, v149
    v_cvt_pk_bf16_f32 v57, v134, v135
    v_cvt_pk_bf16_f32 v59, v150, v151
    ds_write_b128 v14, v[56:59] offset:3072
    s_waitcnt lgkmcnt(0)
    ds_read_b128 v[112:115], v12 offset:0
    ds_read_b128 v[116:119], v12 offset:1024
    ds_read_b128 v[120:123], v12 offset:2048
    ds_read_b128 v[124:127], v12 offset:3072
    s_waitcnt lgkmcnt(3)
    buffer_store_dwordx4 v[112:115], v15, s[20:23], s41 offen sc1
    s_add_u32 s41, s41, 557056
    s_waitcnt lgkmcnt(2)
    buffer_store_dwordx4 v[116:119], v15, s[20:23], s41 offen sc1
    s_add_u32 s41, s41, 557056
    s_waitcnt lgkmcnt(1)
    buffer_store_dwordx4 v[120:123], v15, s[20:23], s41 offen sc1
    s_add_u32 s41, s41, 557056
    s_waitcnt lgkmcnt(0)
    buffer_store_dwordx4 v[124:127], v15, s[20:23], s41 offen sc1
    s_setprio 0
    v_mov_b32 v10, 149504
    s_mov_b32 s53, 7
    s_nop 0
L_ksp:
    ds_read_b32 v11, v10
    s_waitcnt lgkmcnt(0)
    v_readfirstlane_b32 s52, v11
    s_nop 1
    s_cmp_lg_u32 s52, 0
    s_nop 1
    s_cbranch_scc1 L_hwX
    s_sleep 1
    s_sub_u32 s53, s53, 1
    s_cmp_lg_u32 s53, 0
    s_cbranch_scc1 L_ksp
    s_and_b32 s52, s5, 7
    s_lshl_b32 s52, s52, 8
    s_add_u32 s52, s52, 12603392
    v_mov_b32 v10, 149504
    v_mov_b32 v11, 1
    v_lshlrev_b32 v12, 11, v2
    s_waitcnt vmcnt(0)
    s_mov_b64 exec, 1
    ds_add_rtn_u32 v10, v10, v11 offset:8
    s_waitcnt lgkmcnt(0)
    v_readfirstlane_b32 s53, v10
    s_nop 1
    s_add_u32 s53, s53, 1
    s_cmp_lg_u32 s53, s42
    s_nop 0
    s_cbranch_scc1 L_nod1a
    s_mov_b64 exec, 0xff
    buffer_atomic_add v11, v12, s[20:23], s52 offen sc1
    s_nop 1
L_nod1a:
    s_mov_b64 exec, -1
    s_mov_b32 s48, 0
    s_branch L_hwX
L_s7b:
    s_lshl_b32 s68, s4, 2
    s_and_b32 s52, s5, 3
    s_add_u32 s68, s68, s52
    s_lshr_b32 s69, s5, 2
    s_lshl_b32 s70, s68, 1
    s_lshr_b32 s52, s6, 1
    s_add_u32 s70, s70, s52
    s_and_b32 s71, s6, 1
    s_mul_i32 s72, s70, 88
    s_lshl_b32 s52, s7, 1
    s_add_u32 s72, s72, s52
    s_add_u32 s72, s72, s71
    s_lshl_b32 s72, s72, 10
    s_lshl_b32 s73, s3, 11
    s_cmp_ge_u32 s3, 6
    s_cselect_b32 s77, 1277952, -1
    s_mul_i32 s74, s68, 69632
    s_add_u32 s74, s74, 9437184
    s_and_b32 s52, s5, 3
    s_mul_i32 s52, s52, 3
    s_add_u32 s75, s69, s4
    s_add_u32 s75, s75, s52
    s_cmp_ge_u32 s75, 11
    s_cselect_b32 s52, 11, 0
    s_sub_u32 s75, s75, s52
    s_cmp_ge_u32 s75, 11
    s_cselect_b32 s52, 11, 0
    s_sub_u32 s75, s75, s52
    v_lshrrev_b32 v10, 3, v2
    v_and_b32 v11, 7, v2
    v_and_b32 v12, 6, v10
    v_xor_b32 v11, v11, v12
    s_lshl_b32 s52, s3, 14
    s_lshl_b32 s53, s69, 7
    s_add_u32 s52, s52, s53
    v_lshlrev_b32 v10, 10, v10
    v_lshl_add_u32 v10, v11, 4, v10
    v_add_u32 v247, s52, v10
    s_lshl_b32 s52, s71, 20
    s_lshl_b32 s53, s70, 10
    s_add_u32 s52, s52, s53
    s_lshl_b32 s53, s69, 7
    s_add_u32 s52, s52, s53
    s_lshl_b32 s53, s7, 6
    s_add_u32 s52, s52, s53
    v_lshlrev_b32 v253, 16, v3
    v_lshl_add_u32 v253, v4, 3, v253
    v_add_u32 v253, s52, v253
    v_and_b32 v10, 1, v4
    v_mul_u32_u24 v10, 24, v10
    v_add_u32 v253, v10, v253
    buffer_load_dwordx4 v[232:235], v253, s[8:11], 0 offen
    v_lshrrev_b32 v10, 2, v3
    v_lshl_add_u32 v10, v4, 2, v10
    v_and_b32 v11, 6, v10
    v_and_b32 v12, 3, v2
    v_lshrrev_b32 v13, 1, v12
    v_xor_b32 v11, v11, v13
    v_and_b32 v12, 1, v12
    v_lshlrev_b32 v10, 7, v10
    v_lshl_add_u32 v10, v12, 3, v10
    s_lshl_b32 s52, s7, 13
    s_lshl_b32 s53, s71, 12
    s_add_u32 s52, s52, s53
    v_add_u32 v10, s52, v10
    s_mul_i32 s52, s71, 45056
    s_sub_u32 s53, 45056, s52
    v_add_u32 v248, s52, v5
    v_add_u32 v249, s53, v5
    s_lshl_b32 s52, s7, 2
    v_xor_b32 v11, s52, v11
    v_xor_b32 v12, 0, v11
    v_lshl_add_u32 v224, v12, 4, v10
    v_add_u32 v228, 0x10000, v224
    v_add_u32 v240, 0x20000, v224
    v_xor_b32 v12, 2, v11
    v_lshl_add_u32 v225, v12, 4, v10
    v_add_u32 v229, 0x10000, v225
    v_add_u32 v241, 0x20000, v225
    v_xor_b32 v12, 4, v11
    v_lshl_add_u32 v226, v12, 4, v10
    v_add_u32 v230, 0x10000, v226
    v_add_u32 v242, 0x20000, v226
    v_xor_b32 v12, 6, v11
    v_lshl_add_u32 v227, v12, 4, v10
    v_add_u32 v231, 0x10000, v227
    v_add_u32 v243, 0x20000, v227
    v_lshrrev_b32 v10, 3, v3
    v_and_b32 v11, 1, v4
    v_lshl_add_u32 v10, v10, 1, v11
    s_lshl_b32 s52, s71, 1
    v_xor_b32 v10, s52, v10
    v_lshlrev_b32 v10, 4, v10
    v_lshl_add_u32 v10, v3, 6, v10
    s_lshr_b32 s52, s6, 1
    s_lshl_b32 s52, s52, 11
    s_add_u32 s53, s52, 151552
    s_add_u32 s52, s52, 114688
    v_add_u32 v237, s53, v10
    v_lshrrev_b32 v11, 1, v4
    v_lshl_add_u32 v10, v11, 12, v10
    v_add_u32 v236, s52, v10
    v_subrev_u32 v238, 98304, v236
    v_lshl_add_u32 v10, v3, 6, s70
    v_lshlrev_b32 v11, 2, v4
    v_mul_u32_u24 v11, v10, v11
    v_and_b32 v11, 2047, v11
    v_cvt_f32_u32 v11, v11
    v_cvt_f32_u32 v10, v10
    v_mul_f32 v11, 0x3a000000, v11
    v_mul_f32 v10, 0x3a000000, v10
    v_cos_f32 v48, v11
    v_sin_f32 v56, v11
    v_fmamk_f32 v12, v10, 0x3f800000, v11
    v_fract_f32 v12, v12
    v_cos_f32 v49, v12
    v_sin_f32 v57, v12
    v_fmamk_f32 v12, v10, 0x40000000, v11
    v_fract_f32 v12, v12
    v_cos_f32 v50, v12
    v_sin_f32 v58, v12
    v_fmamk_f32 v12, v10, 0x40400000, v11
    v_fract_f32 v12, v12
    v_cos_f32 v51, v12
    v_sin_f32 v59, v12
    v_fmamk_f32 v12, v10, 0x41800000, v11
    v_fract_f32 v12, v12
    v_cos_f32 v52, v12
    v_sin_f32 v60, v12
    v_fmamk_f32 v12, v10, 0x41880000, v11
    v_fract_f32 v12, v12
    v_cos_f32 v53, v12
    v_sin_f32 v61, v12
    v_fmamk_f32 v12, v10, 0x41900000, v11
    v_fract_f32 v12, v12
    v_cos_f32 v54, v12
    v_sin_f32 v62, v12
    v_fmamk_f32 v12, v10, 0x41980000, v11
    v_fract_f32 v12, v12
    v_cos_f32 v55, v12
    v_sin_f32 v63, v12
    v_cvt_pk_bf16_f32 v208, v48, v49
    v_cvt_pk_bf16_f32 v212, -v56, -v57
    v_cvt_pk_bf16_f32 v209, v50, v51
    v_cvt_pk_bf16_f32 v213, -v58, -v59
    v_cvt_pk_bf16_f32 v210, v52, v53
    v_cvt_pk_bf16_f32 v214, -v60, -v61
    v_cvt_pk_bf16_f32 v211, v54, v55
    v_cvt_pk_bf16_f32 v215, -v62, -v63
    v_xor_b32 v216, 0x80000000, v208
    v_xor_b32 v217, 0x80000000, v209
    v_xor_b32 v218, 0x80000000, v210
    v_xor_b32 v219, 0x80000000, v211
    v_xor_b32 v220, 0x80000000, v212
    v_xor_b32 v221, 0x80000000, v213
    v_xor_b32 v222, 0x80000000, v214
    v_xor_b32 v223, 0x80000000, v215
    s_add_u32 s52, s75, 4
    s_cmp_ge_u32 s52, 11
    s_cselect_b32 s53, 11, 0
    s_sub_u32 s52, s52, s53
    s_lshl_b32 s52, s52, 12
    s_add_u32 s61, s52, s72
    s_add_u32 s53, s72, 45056
    s_add_u32 s52, s61, 4096
    s_cmp_eq_u32 s52, s53
    s_cselect_b32 s62, s72, s52
    s_add_u32 s52, s62, 4096
    s_cmp_eq_u32 s52, s53
    s_cselect_b32 s63, s72, s52
    s_add_u32 s52, s63, 4096
    s_cmp_eq_u32 s52, s53
    s_cselect_b32 s64, s72, s52
    s_add_u32 s52, s64, 4096
    s_cmp_eq_u32 s52, s53
    s_cselect_b32 s65, s72, s52
    s_add_u32 s52, s65, 4096
    s_cmp_eq_u32 s52, s53
    s_cselect_b32 s66, s72, s52
    s_add_u32 s52, s66, 4096
    s_cmp_eq_u32 s52, s53
    s_cselect_b32 s67, s72, s52
    s_sub_u32 s52, s65, s72
    s_lshl_b32 s52, s52, 5
    s_min_u32 s45, s52, s77
    s_sub_u32 s52, s66, s72
    s_lshl_b32 s52, s52, 5
    s_min_u32 s46, s52, s77
    s_sub_u32 s52, s67, s72
    s_lshl_b32 s52, s52, 5
    s_min_u32 s50, s52, s77
    s_waitcnt vmcnt(1) lgkmcnt(0)
    s_barrier
    s_barrier
    s_lshl_b32 s52, s69, 6
    s_lshl_b32 s53, s7, 5
    s_add_u32 s52, s52, s53
    s_add_u32 s52, s52, s71
    v_and_b32 v10, 12, v3
    v_and_b32 v11, 2, v3
    v_lshl_add_u32 v10, v11, 3, v10
    v_and_b32 v11, 1, v3
    v_lshl_add_u32 v10, v11, 1, v10
    v_add_u32 v10, s52, v10
    v_lshlrev_b32 v11, 2, v4
    v_mul_u32_u24 v11, v10, v11
    v_and_b32 v11, 511, v11
    v_lshlrev_b32 v12, 4, v10
    v_and_b32 v12, 511, v12
    v_cvt_f32_u32 v10, v10
    v_cvt_f32_u32 v11, v11
    v_cvt_f32_u32 v12, v12
    v_mul_f32 v10, 0x3b000000, v10
    v_mul_f32 v11, 0x3b000000, v11
    v_mul_f32 v12, 0x3b000000, v12
    v_cos_f32 v168, v11
    v_sin_f32 v169, v11
    v_cos_f32 v170, v10
    v_sin_f32 v171, v10
    v_cos_f32 v172, v12
    v_sin_f32 v173, v12
    s_lshl_b32 s52, s71, 31
    s_xor_b32 s52, s52, 0xb638aa3b
    v_mul_f32 v168, s52, v168
    v_mul_f32 v169, s52, v169
    v_cmp_eq_u32 vcc, 0, v4
    s_nop 1
    v_cndmask_b32 v174, 1.0, 0.5, vcc
    v_mul_f32 v8, v168, v170
    v_mul_f32 v13, v169, v170
    v_mul_f32 v175, v168, v172
    v_mul_f32 v12, v169, v172
    v_fma_f32 v8, -v169, v171, v8
    v_fmac_f32 v13, v168, v171
    v_fma_f32 v175, -v169, v173, v175
    v_fmac_f32 v12, v168, v173
    v_mul_f32 v14, v8, v170
    v_mul_f32 v15, v13, v170
    v_fma_f32 v14, -v13, v171, v14
    v_fmac_f32 v15, v8, v171
    v_mul_f32 v10, v14, v170
    v_mul_f32 v11, v15, v170
    v_fma_f32 v10, -v15, v171, v10
    v_fmac_f32 v11, v14, v171
    v_mul_f32 v168, v168, v174
    v_cvt_pk_bf16_f32 v16, v168, v8
    v_cvt_pk_bf16_f32 v17, v14, v10
    v_cvt_pk_bf16_f32 v18, -v169, -v13
    v_cvt_pk_bf16_f32 v19, -v15, -v11
    v_mul_f32 v8, v175, v170
    v_mul_f32 v13, v12, v170
    v_mul_f32 v168, v175, v172
    v_mul_f32 v169, v12, v172
    v_fma_f32 v8, -v12, v171, v8
    v_fmac_f32 v13, v175, v171
    v_fma_f32 v168, -v12, v173, v168
    v_fmac_f32 v169, v175, v173
    v_mul_f32 v14, v8, v170
    v_mul_f32 v15, v13, v170
    v_fma_f32 v14, -v13, v171, v14
    v_fmac_f32 v15, v8, v171
    v_mul_f32 v10, v14, v170
    v_mul_f32 v11, v15, v170
    v_fma_f32 v10, -v15, v171, v10
    v_fmac_f32 v11, v14, v171
    v_cvt_pk_bf16_f32 v20, v175, v8
    v_cvt_pk_bf16_f32 v21, v14, v10
    v_cvt_pk_bf16_f32 v22, -v12, -v13
    v_cvt_pk_bf16_f32 v23, -v15, -v11
    v_mul_f32 v8, v168, v170
    v_mul_f32 v13, v169, v170
    v_mul_f32 v175, v168, v172
    v_mul_f32 v12, v169, v172
    v_fma_f32 v8, -v169, v171, v8
    v_fmac_f32 v13, v168, v171
    v_fma_f32 v175, -v169, v173, v175
    v_fmac_f32 v12, v168, v173
    v_mul_f32 v14, v8, v170
    v_mul_f32 v15, v13, v170
    v_fma_f32 v14, -v13, v171, v14
    v_fmac_f32 v15, v8, v171
    v_mul_f32 v10, v14, v170
    v_mul_f32 v11, v15, v170
    v_fma_f32 v10, -v15, v171, v10
    v_fmac_f32 v11, v14, v171
    v_cvt_pk_bf16_f32 v24, v168, v8
    v_cvt_pk_bf16_f32 v25, v14, v10
    v_cvt_pk_bf16_f32 v26, -v169, -v13
    v_cvt_pk_bf16_f32 v27, -v15, -v11
    v_mul_f32 v8, v175, v170
    v_mul_f32 v13, v12, v170
    v_mul_f32 v168, v175, v172
    v_mul_f32 v169, v12, v172
    v_fma_f32 v8, -v12, v171, v8
    v_fmac_f32 v13, v175, v171
    v_fma_f32 v168, -v12, v173, v168
    v_fmac_f32 v169, v175, v173
    v_mul_f32 v14, v8, v170
    v_mul_f32 v15, v13, v170
    v_fma_f32 v14, -v13, v171, v14
    v_fmac_f32 v15, v8, v171
    v_mul_f32 v10, v14, v170
    v_mul_f32 v11, v15, v170
    v_fma_f32 v10, -v15, v171, v10
    v_fmac_f32 v11, v14, v171
    v_cvt_pk_bf16_f32 v28, v175, v8
    v_cvt_pk_bf16_f32 v29, v14, v10
    v_cvt_pk_bf16_f32 v30, -v12, -v13
    v_cvt_pk_bf16_f32 v31, -v15, -v11
    v_mul_f32 v8, v168, v170
    v_mul_f32 v13, v169, v170
    v_mul_f32 v175, v168, v172
    v_mul_f32 v12, v169, v172
    v_fma_f32 v8, -v169, v171, v8
    v_fmac_f32 v13, v168, v171
    v_fma_f32 v175, -v169, v173, v175
    v_fmac_f32 v12, v168, v173
    v_mul_f32 v14, v8, v170
    v_mul_f32 v15, v13, v170
    v_fma_f32 v14, -v13, v171, v14
    v_fmac_f32 v15, v8, v171
    v_mul_f32 v10, v14, v170
    v_mul_f32 v11, v15, v170
    v_fma_f32 v10, -v15, v171, v10
    v_fmac_f32 v11, v14, v171
    v_cvt_pk_bf16_f32 v32, v168, v8
    v_cvt_pk_bf16_f32 v33, v14, v10
    v_cvt_pk_bf16_f32 v34, -v169, -v13
    v_cvt_pk_bf16_f32 v35, -v15, -v11
    v_mul_f32 v8, v175, v170
    v_mul_f32 v13, v12, v170
    v_mul_f32 v168, v175, v172
    v_mul_f32 v169, v12, v172
    v_fma_f32 v8, -v12, v171, v8
    v_fmac_f32 v13, v175, v171
    v_fma_f32 v168, -v12, v173, v168
    v_fmac_f32 v169, v175, v173
    v_mul_f32 v14, v8, v170
    v_mul_f32 v15, v13, v170
    v_fma_f32 v14, -v13, v171, v14
    v_fmac_f32 v15, v8, v171
    v_mul_f32 v10, v14, v170
    v_mul_f32 v11, v15, v170
    v_fma_f32 v10, -v15, v171, v10
    v_fmac_f32 v11, v14, v171
    v_cvt_pk_bf16_f32 v36, v175, v8
    v_cvt_pk_bf16_f32 v37, v14, v10
    v_cvt_pk_bf16_f32 v38, -v12, -v13
    v_cvt_pk_bf16_f32 v39, -v15, -v11
    v_mul_f32 v8, v168, v170
    v_mul_f32 v13, v169, v170
    v_mul_f32 v175, v168, v172
    v_mul_f32 v12, v169, v172
    v_fma_f32 v8, -v169, v171, v8
    v_fmac_f32 v13, v168, v171
    v_fma_f32 v175, -v169, v173, v175
    v_fmac_f32 v12, v168, v173
    v_mul_f32 v14, v8, v170
    v_mul_f32 v15, v13, v170
    v_fma_f32 v14, -v13, v171, v14
    v_fmac_f32 v15, v8, v171
    v_mul_f32 v10, v14, v170
    v_mul_f32 v11, v15, v170
    v_fma_f32 v10, -v15, v171, v10
    v_fmac_f32 v11, v14, v171
    v_cvt_pk_bf16_f32 v40, v168, v8
    v_cvt_pk_bf16_f32 v41, v14, v10
    v_cvt_pk_bf16_f32 v42, -v169, -v13
    v_cvt_pk_bf16_f32 v43, -v15, -v11
    v_mul_f32 v8, v175, v170
    v_mul_f32 v13, v12, v170
    v_fma_f32 v8, -v12, v171, v8
    v_fmac_f32 v13, v175, v171
    v_mul_f32 v14, v8, v170
    v_mul_f32 v15, v13, v170
    v_fma_f32 v14, -v13, v171, v14
    v_fmac_f32 v15, v8, v171
    v_mul_f32 v10, v14, v170
    v_mul_f32 v11, v15, v170
    v_fma_f32 v10, -v15, v171, v10
    v_fmac_f32 v11, v14, v171
    v_cvt_pk_bf16_f32 v44, v175, v8
    v_cvt_pk_bf16_f32 v45, v14, v10
    v_cvt_pk_bf16_f32 v46, -v12, -v13
    v_cvt_pk_bf16_f32 v47, -v15, -v11
    s_mov_b32 s52, s75
    s_lshl_b32 s52, s52, 17
    s_min_u32 s52, s52, s77
    s_add_u32 m0, s73, 81920
    s_nop 0
    buffer_load_dwordx4 v247, s[16:19], s52 offen lds
    s_add_u32 s52, s52, 8192
    s_add_u32 m0, s73, 82944
    s_nop 0
    buffer_load_dwordx4 v247, s[16:19], s52 offen lds
    s_add_u32 s52, s75, 1
    s_cmp_ge_u32 s52, 11
    s_cselect_b32 s53, 11, 0
    s_sub_u32 s52, s52, s53
    s_lshl_b32 s52, s52, 17
    s_min_u32 s52, s52, s77
    s_add_u32 m0, s73, 98304
    s_nop 0
    buffer_load_dwordx4 v247, s[16:19], s52 offen lds
    s_add_u32 s52, s52, 8192
    s_add_u32 m0, s73, 99328
    s_nop 0
    buffer_load_dwordx4 v247, s[16:19], s52 offen lds
    s_add_u32 s52, s75, 2
    s_cmp_ge_u32 s52, 11
    s_cselect_b32 s53, 11, 0
    s_sub_u32 s52, s52, s53
    s_lshl_b32 s52, s52, 17
    s_min_u32 s52, s52, s77
    s_add_u32 m0, s73, 114688
    s_nop 0
    buffer_load_dwordx4 v247, s[16:19], s52 offen lds
    s_add_u32 s52, s52, 8192
    s_add_u32 m0, s73, 115712
    s_nop 0
    buffer_load_dwordx4 v247, s[16:19], s52 offen lds
    s_add_u32 s52, s75, 3
    s_cmp_ge_u32 s52, 11
    s_cselect_b32 s53, 11, 0
    s_sub_u32 s52, s52, s53
    s_lshl_b32 s52, s52, 17
    s_min_u32 s52, s52, s77
    s_add_u32 m0, s73, 131072
    s_nop 0
    buffer_load_dwordx4 v247, s[16:19], s52 offen lds
    s_add_u32 s52, s52, 8192
    s_add_u32 m0, s73, 132096
    s_nop 0
    buffer_load_dwordx4 v247, s[16:19], s52 offen lds
    s_add_u32 s52, s75, 4
    s_cmp_ge_u32 s52, 11
    s_cselect_b32 s53, 11, 0
    s_sub_u32 s52, s52, s53
    s_lshl_b32 s52, s52, 17
    s_min_u32 s52, s52, s77
    s_add_u32 m0, s73, 16384
    s_nop 0
    buffer_load_dwordx4 v247, s[16:19], s52 offen lds
    s_add_u32 s52, s52, 8192
    s_add_u32 m0, s73, 17408
    s_nop 0
    buffer_load_dwordx4 v247, s[16:19], s52 offen lds
    s_add_u32 s52, s75, 5
    s_cmp_ge_u32 s52, 11
    s_cselect_b32 s53, 11, 0
    s_sub_u32 s52, s52, s53
    s_lshl_b32 s52, s52, 17
    s_min_u32 s52, s52, s77
    s_add_u32 m0, s73, 32768
    s_nop 0
    buffer_load_dwordx4 v247, s[16:19], s52 offen lds
    s_add_u32 s52, s52, 8192
    s_add_u32 m0, s73, 33792
    s_nop 0
    buffer_load_dwordx4 v247, s[16:19], s52 offen lds
    s_add_u32 s52, s75, 6
    s_cmp_ge_u32 s52, 11
    s_cselect_b32 s53, 11, 0
    s_sub_u32 s52, s52, s53
    s_lshl_b32 s52, s52, 17
    s_min_u32 s52, s52, s77
    s_add_u32 m0, s73, 49152
    s_nop 0
    buffer_load_dwordx4 v247, s[16:19], s52 offen lds
    s_add_u32 s52, s52, 8192
    s_add_u32 m0, s73, 50176
    s_nop 0
    buffer_load_dwordx4 v247, s[16:19], s52 offen lds
    s_add_u32 s52, s75, 7
    s_cmp_ge_u32 s52, 11
    s_cselect_b32 s53, 11, 0
    s_sub_u32 s52, s52, s53
    s_lshl_b32 s52, s52, 17
    s_min_u32 s52, s52, s77
    s_add_u32 m0, s73, 65536
    s_nop 0
    buffer_load_dwordx4 v247, s[16:19], s52 offen lds
    s_add_u32 s52, s52, 8192
    s_add_u32 m0, s73, 66560
    s_nop 0
    buffer_load_dwordx4 v247, s[16:19], s52 offen lds
    s_branch L_ph
L_F_end:
    v_mov_b32 v9, 0
    s_cmp_eq_u32 s48, 0
    s_nop 0
    s_cbranch_scc1 L_fn
    s_lshl_b32 s55, s68, 11
    s_add_u32 s55, s55, 12632064
    s_lshr_b32 s52, s47, 2
    s_lshl_b32 s52, s52, 8
    s_add_u32 s55, s55, s52
    s_setprio 3
    v_mov_b64 v[160:161], 0
    v_mov_b64 v[162:163], 0
    v_mov_b64 v[164:165], 0
    v_mov_b64 v[166:167], 0
    v_mov_b64 v[168:169], 0
    v_mov_b64 v[170:171], 0
    v_mov_b64 v[172:173], 0
    v_mov_b64 v[174:175], 0
    v_mov_b64 v[176:177], 0
    v_mov_b64 v[178:179], 0
    v_mov_b64 v[180:181], 0
    v_mov_b64 v[182:183], 0
    v_mov_b64 v[184:185], 0
    v_mov_b64 v[186:187], 0
    v_mov_b64 v[188:189], 0
    v_mov_b64 v[190:191], 0
    v_lshlrev_b32 v10, 1, v3
    v_add_u32 v11, s1, v10
    v_sub_u32 v10, s101, v10
    v_cmp_gt_u32 vcc, 8, v3
    s_nop 1
    v_cndmask_b32 v10, v10, v11, vcc
    v_cndmask_b32 v200, -1.0, 1.0, vcc
    v_and_b32 v201, 0x80000000, v200
    v_lshrrev_b32 v11, 4, v10
    v_lshlrev_b32 v12, 1, v4
    v_xor_b32 v11, v11, v12
    v_and_b32 v10, 15, v10
    v_lshl_add_u32 v10, v11, 4, v10
    v_lshl_add_u32 v10, v4, 10, v10
    v_add_u32 v10, 131072, v10
    ds_read_u16_d16_hi v160, v10 offset:0
    ds_read_u16_d16_hi v161, v10 offset:8192
    ds_read_u16_d16_hi v162, v10 offset:256
    ds_read_u16_d16_hi v163, v10 offset:8448
    ds_read_u16_d16_hi v164, v10 offset:512
    ds_read_u16_d16_hi v165, v10 offset:8704
    ds_read_u16_d16_hi v166, v10 offset:768
    ds_read_u16_d16_hi v167, v10 offset:8960
    ds_read_u16_d16_hi v168, v10 offset:4096
    ds_read_u16_d16_hi v169, v10 offset:12288
    ds_read_u16_d16_hi v170, v10 offset:4352
    ds_read_u16_d16_hi v171, v10 offset:12544
    ds_read_u16_d16_hi v172, v10 offset:4608
    ds_read_u16_d16_hi v173, v10 offset:12800
    ds_read_u16_d16_hi v174, v10 offset:4864
    ds_read_u16_d16_hi v175, v10 offset:13056
    ds_read_u16_d16_hi v176, v10 offset:128
    ds_read_u16_d16_hi v177, v10 offset:8320
    ds_read_u16_d16_hi v178, v10 offset:384
    ds_read_u16_d16_hi v179, v10 offset:8576
    ds_read_u16_d16_hi v180, v10 offset:640
    ds_read_u16_d16_hi v181, v10 offset:8832
    ds_read_u16_d16_hi v182, v10 offset:896
    ds_read_u16_d16_hi v183, v10 offset:9088
    ds_read_u16_d16_hi v184, v10 offset:4224
    ds_read_u16_d16_hi v185, v10 offset:12416
    ds_read_u16_d16_hi v186, v10 offset:4480
    ds_read_u16_d16_hi v187, v10 offset:12672
    ds_read_u16_d16_hi v188, v10 offset:4736
    ds_read_u16_d16_hi v189, v10 offset:12928
    ds_read_u16_d16_hi v190, v10 offset:4992
    ds_read_u16_d16_hi v191, v10 offset:13184
    s_waitcnt lgkmcnt(0)
    v_xor_b32 v161, v201, v161
    v_xor_b32 v163, v201, v163
    v_xor_b32 v165, v201, v165
    v_xor_b32 v167, v201, v167
    v_xor_b32 v169, v201, v169
    v_xor_b32 v171, v201, v171
    v_xor_b32 v173, v201, v173
    v_xor_b32 v175, v201, v175
    v_xor_b32 v177, v201, v177
    v_xor_b32 v179, v201, v179
    v_xor_b32 v181, v201, v181
    v_xor_b32 v183, v201, v183
    v_xor_b32 v185, v201, v185
    v_xor_b32 v187, v201, v187
    v_xor_b32 v189, v201, v189
    v_xor_b32 v191, v201, v191
    s_cmp_lg_u32 s47, 16
    s_nop 0
    s_cbranch_scc1 L_wnomaskF
    v_cmp_eq_u32 vcc, 0, v3
    s_nop 1
    v_cndmask_b32 v160, 0, v160, vcc
    v_cndmask_b32 v161, 0, v161, vcc
    v_cndmask_b32 v162, 0, v162, vcc
    v_cndmask_b32 v163, 0, v163, vcc
    v_cndmask_b32 v164, 0, v164, vcc
    v_cndmask_b32 v165, 0, v165, vcc
    v_cndmask_b32 v166, 0, v166, vcc
    v_cndmask_b32 v167, 0, v167, vcc
    v_cndmask_b32 v168, 0, v168, vcc
    v_cndmask_b32 v169, 0, v169, vcc
    v_cndmask_b32 v170, 0, v170, vcc
    v_cndmask_b32 v171, 0, v171, vcc
    v_cndmask_b32 v172, 0, v172, vcc
    v_cndmask_b32 v173, 0, v173, vcc
    v_cndmask_b32 v174, 0, v174, vcc
    v_cndmask_b32 v175, 0, v175, vcc
    v_cndmask_b32 v176, 0, v176, vcc
    v_cndmask_b32 v177, 0, v177, vcc
    v_cndmask_b32 v178, 0, v178, vcc
    v_cndmask_b32 v179, 0, v179, vcc
    v_cndmask_b32 v180, 0, v180, vcc
    v_cndmask_b32 v181, 0, v181, vcc
    v_cndmask_b32 v182, 0, v182, vcc
    v_cndmask_b32 v183, 0, v183, vcc
    v_cndmask_b32 v184, 0, v184, vcc
    v_cndmask_b32 v185, 0, v185, vcc
    v_cndmask_b32 v186, 0, v186, vcc
    v_cndmask_b32 v187, 0, v187, vcc
    v_cndmask_b32 v188, 0, v188, vcc
    v_cndmask_b32 v189, 0, v189, vcc
    v_cndmask_b32 v190, 0, v190, vcc
    v_cndmask_b32 v191, 0, v191, vcc
    s_nop 1
L_wnomaskF:
    s_waitcnt vmcnt(4)
    v_readfirstlane_b32 s41, v246
    v_add_u32 v12, 151552, v5
    ds_read_b128 v[64:67], v12 offset:0
    ds_read_b128 v[68:71], v12 offset:1024
    ds_read_b128 v[72:75], v12 offset:2048
    ds_read_b128 v[76:79], v12 offset:3072
    ds_read_b128 v[80:83], v12 offset:4096
    ds_read_b128 v[84:87], v12 offset:5120
    ds_read_b128 v[88:91], v12 offset:6144
    ds_read_b128 v[92:95], v12 offset:7168
    ds_read_b128 v[96:99], v12 offset:8192
    ds_read_b128 v[100:103], v12 offset:9216
    ds_read_b128 v[104:107], v12 offset:10240
    ds_read_b128 v[108:111], v12 offset:11264
    v_lshl_add_u32 v10, v3, 6, s70
    v_lshlrev_b32 v11, 2, v4
    v_mul_u32_u24 v11, v10, v11
    v_and_b32 v11, 2047, v11
    v_cvt_f32_u32 v11, v11
    v_cvt_f32_u32 v10, v10
    v_mul_f32 v11, 0x3a000000, v11
    v_mul_f32 v10, 0x3a000000, v10
    v_cos_f32 v48, v11
    v_sin_f32 v56, v11
    v_fmamk_f32 v12, v10, 0x3f800000, v11
    v_fract_f32 v12, v12
    v_cos_f32 v49, v12
    v_sin_f32 v57, v12
    v_fmamk_f32 v12, v10, 0x40000000, v11
    v_fract_f32 v12, v12
    v_cos_f32 v50, v12
    v_sin_f32 v58, v12
    v_fmamk_f32 v12, v10, 0x40400000, v11
    v_fract_f32 v12, v12
    v_cos_f32 v51, v12
    v_sin_f32 v59, v12
    v_fmamk_f32 v12, v10, 0x41800000, v11
    v_fract_f32 v12, v12
    v_cos_f32 v52, v12
    v_sin_f32 v60, v12
    v_fmamk_f32 v12, v10, 0x41880000, v11
    v_fract_f32 v12, v12
    v_cos_f32 v53, v12
    v_sin_f32 v61, v12
    v_fmamk_f32 v12, v10, 0x41900000, v11
    v_fract_f32 v12, v12
    v_cos_f32 v54, v12
    v_sin_f32 v62, v12
    v_fmamk_f32 v12, v10, 0x41980000, v11
    v_fract_f32 v12, v12
    v_cos_f32 v55, v12
    v_sin_f32 v63, v12
    v_cvt_pk_bf16_f32 v208, v48, v49
    v_cvt_pk_bf16_f32 v212, -v56, -v57
    v_cvt_pk_bf16_f32 v209, v50, v51
    v_cvt_pk_bf16_f32 v213, -v58, -v59
    v_cvt_pk_bf16_f32 v210, v52, v53
    v_cvt_pk_bf16_f32 v214, -v60, -v61
    v_cvt_pk_bf16_f32 v211, v54, v55
    v_cvt_pk_bf16_f32 v215, -v62, -v63
    v_xor_b32 v216, 0x80000000, v208
    v_xor_b32 v217, 0x80000000, v209
    v_xor_b32 v218, 0x80000000, v210
    v_xor_b32 v219, 0x80000000, v211
    v_xor_b32 v220, 0x80000000, v212
    v_xor_b32 v221, 0x80000000, v213
    v_xor_b32 v222, 0x80000000, v214
    v_xor_b32 v223, 0x80000000, v215
    s_add_u32 s52, s75, 4
    s_cmp_ge_u32 s52, 11
    s_cselect_b32 s53, 11, 0
    s_sub_u32 s52, s52, s53
    s_lshl_b32 s52, s52, 12
    s_add_u32 s61, s52, s72
    s_add_u32 s53, s72, 45056
    s_add_u32 s52, s61, 4096
    s_cmp_eq_u32 s52, s53
    s_cselect_b32 s62, s72, s52
    s_add_u32 s52, s62, 4096
    s_cmp_eq_u32 s52, s53
    s_cselect_b32 s63, s72, s52
    s_add_u32 s52, s63, 4096
    s_cmp_eq_u32 s52, s53
    s_cselect_b32 s64, s72, s52
    s_add_u32 s52, s64, 4096
    s_cmp_eq_u32 s52, s53
    s_cselect_b32 s65, s72, s52
    s_add_u32 s52, s65, 4096
    s_cmp_eq_u32 s52, s53
    s_cselect_b32 s66, s72, s52
    s_add_u32 s52, s66, 4096
    s_cmp_eq_u32 s52, s53
    s_cselect_b32 s67, s72, s52
    s_sub_u32 s52, s65, s72
    s_lshl_b32 s52, s52, 5
    s_min_u32 s45, s52, s77
    s_sub_u32 s52, s66, s72
    s_lshl_b32 s52, s52, 5
    s_min_u32 s46, s52, s77
    s_sub_u32 s52, s67, s72
    s_lshl_b32 s52, s52, 5
    s_min_u32 s50, s52, s77
    s_buffer_load_dword s56, s[20:23], s55 offset:0 glc
    s_waitcnt lgkmcnt(0)
    s_cmp_eq_u32 s41, 0
    s_cselect_b32 s56, 0, s56
    s_cmp_ge_u32 s56, 16
    s_cbranch_scc1 L_faearly
    s_buffer_load_dword s56, s[20:23], s55 offset:0 glc
    s_waitcnt vmcnt(0)
    v_readfirstlane_b32 s41, v246
    s_barrier
    s_waitcnt lgkmcnt(0)
    s_cmp_eq_u32 s41, 0
    s_cselect_b32 s56, 0, s56
    s_cmp_lt_u32 s56, 16
    s_cbranch_scc1 L_falate2
    s_lshl_b32 s52, s51, 12
    s_add_u32 s52, s52, 6291456
    s_mov_b32 m0, s49
    s_nop 0
    buffer_load_dwordx4 v5, s[20:23], s52 offen offset:0 sc1 lds
    buffer_load_dwordx4 v5, s[20:23], s52 offen offset:1024 sc1 lds
    buffer_load_dwordx4 v5, s[20:23], s52 offen offset:2048 sc1 lds
    buffer_load_dwordx4 v5, s[20:23], s52 offen offset:3072 sc1 lds
    s_barrier
    s_branch L_fago
L_faearly:
    s_lshl_b32 s52, s51, 12
    s_add_u32 s52, s52, 6291456
    s_mov_b32 m0, s49
    s_nop 0
    buffer_load_dwordx4 v5, s[20:23], s52 offen offset:0 sc1 lds
    buffer_load_dwordx4 v5, s[20:23], s52 offen offset:1024 sc1 lds
    buffer_load_dwordx4 v5, s[20:23], s52 offen offset:2048 sc1 lds
    buffer_load_dwordx4 v5, s[20:23], s52 offen offset:3072 sc1 lds
L_faearly2:
    s_waitcnt vmcnt(4)
    s_barrier
    s_barrier
    s_branch L_fago
L_falate2:
    s_barrier
    v_readfirstlane_b32 s52, v246
    s_nop 1
    s_cmp_lg_u32 s52, 0
    s_nop 1
    s_cbranch_scc1 L_ig_okFA
L_igFA:
    s_sleep 2
    s_buffer_load_dword s52, s[36:39], 0 glc
    s_waitcnt lgkmcnt(0)
    s_cmp_eq_u32 s52, 0
    s_cbranch_scc1 L_igFA
L_ig_okFA:
L_pollAF:
    s_buffer_load_dword s56, s[20:23], s55 offset:0 glc
    s_waitcnt lgkmcnt(0)
    s_cmp_lt_u32 s56, 16
    s_cbranch_scc1 L_pollAF
    s_lshl_b32 s52, s51, 12
    s_add_u32 s52, s52, 6291456
    s_mov_b32 m0, s49
    s_nop 0
    buffer_load_dwordx4 v5, s[20:23], s52 offen offset:0 sc1 lds
    buffer_load_dwordx4 v5, s[20:23], s52 offen offset:1024 sc1 lds
    buffer_load_dwordx4 v5, s[20:23], s52 offen offset:2048 sc1 lds
    buffer_load_dwordx4 v5, s[20:23], s52 offen offset:3072 sc1 lds
L_fago:
    buffer_load_dwordx4 v[232:235], v253, s[8:11], 0 offen
    v_lshrrev_b32 v13, 2, v3
    v_lshl_add_u32 v13, v4, 2, v13
    v_lshlrev_b32 v13, 6, v13
    v_and_b32 v11, 3, v2
    v_lshl_add_u32 v13, v11, 4, v13
    v_add_u32 v13, s49, v13
    v_bfe_u32 v14, v3, 1, 2
    v_xor_b32 v14, v14, v4
    v_lshlrev_b32 v14, 4, v14
    v_lshl_add_u32 v14, v3, 6, v14
    v_add_u32 v14, s49, v14
    v_add_u32 v12, s49, v5
    s_lshl_b32 s52, s47, 12
    s_lshl_b32 s53, s100, 6
    s_add_u32 s52, s52, s53
    s_add_u32 s41, s52, 9437184
    s_mov_b32 s53, 69632
    v_lshrrev_b32 v15, 3, v2
    v_mul_lo_u32 v15, v15, s53
    v_and_b32 v11, 4, v2
    v_lshl_add_u32 v15, v11, 9, v15
    s_lshr_b32 s52, s100, 2
    s_and_b32 s52, s52, 2
    v_lshrrev_b32 v11, 3, v2
    v_xor_b32 v11, v11, v2
    v_xor_b32 v11, s52, v11
    v_and_b32 v11, 3, v11
    v_lshl_add_u32 v15, v11, 4, v15
    s_waitcnt vmcnt(1)
    s_nop 0
    s_branch L_p2
L_fn:
    s_sub_u32 s52, s3, 3
    s_cmp_lt_u32 s52, s42
    s_cbranch_scc1 L_fh
    s_cmp_eq_u32 s3, 6
    s_cbranch_scc1 L_fh
    s_cmp_lg_u32 s3, 7
    s_cbranch_scc1 L_fn7
    buffer_load_dwordx4 v[232:235], v253, s[8:11], 0 offen
    v_lshl_add_u32 v10, v3, 6, s70
    v_lshlrev_b32 v11, 2, v4
    v_mul_u32_u24 v11, v10, v11
    v_and_b32 v11, 2047, v11
    v_cvt_f32_u32 v11, v11
    v_cvt_f32_u32 v10, v10
    v_mul_f32 v11, 0x3a000000, v11
    v_mul_f32 v10, 0x3a000000, v10
    v_cos_f32 v48, v11
    v_sin_f32 v56, v11
    v_fmamk_f32 v12, v10, 0x3f800000, v11
    v_fract_f32 v12, v12
    v_cos_f32 v49, v12
    v_sin_f32 v57, v12
    v_fmamk_f32 v12, v10, 0x40000000, v11
    v_fract_f32 v12, v12
    v_cos_f32 v50, v12
    v_sin_f32 v58, v12
    v_fmamk_f32 v12, v10, 0x40400000, v11
    v_fract_f32 v12, v12
    v_cos_f32 v51, v12
    v_sin_f32 v59, v12
    v_fmamk_f32 v12, v10, 0x41800000, v11
    v_fract_f32 v12, v12
    v_cos_f32 v52, v12
    v_sin_f32 v60, v12
    v_fmamk_f32 v12, v10, 0x41880000, v11
    v_fract_f32 v12, v12
    v_cos_f32 v53, v12
    v_sin_f32 v61, v12
    v_fmamk_f32 v12, v10, 0x41900000, v11
    v_fract_f32 v12, v12
    v_cos_f32 v54, v12
    v_sin_f32 v62, v12
    v_fmamk_f32 v12, v10, 0x41980000, v11
    v_fract_f32 v12, v12
    v_cos_f32 v55, v12
    v_sin_f32 v63, v12
    v_cvt_pk_bf16_f32 v208, v48, v49
    v_cvt_pk_bf16_f32 v212, -v56, -v57
    v_cvt_pk_bf16_f32 v209, v50, v51
    v_cvt_pk_bf16_f32 v213, -v58, -v59
    v_cvt_pk_bf16_f32 v210, v52, v53
    v_cvt_pk_bf16_f32 v214, -v60, -v61
    v_cvt_pk_bf16_f32 v211, v54, v55
    v_cvt_pk_bf16_f32 v215, -v62, -v63
    v_xor_b32 v216, 0x80000000, v208
    v_xor_b32 v217, 0x80000000, v209
    v_xor_b32 v218, 0x80000000, v210
    v_xor_b32 v219, 0x80000000, v211
    v_xor_b32 v220, 0x80000000, v212
    v_xor_b32 v221, 0x80000000, v213
    v_xor_b32 v222, 0x80000000, v214
    v_xor_b32 v223, 0x80000000, v215
    s_add_u32 s52, s75, 4
    s_cmp_ge_u32 s52, 11
    s_cselect_b32 s53, 11, 0
    s_sub_u32 s52, s52, s53
    s_lshl_b32 s52, s52, 12
    s_add_u32 s61, s52, s72
    s_add_u32 s53, s72, 45056
    s_add_u32 s52, s61, 4096
    s_cmp_eq_u32 s52, s53
    s_cselect_b32 s62, s72, s52
    s_add_u32 s52, s62, 4096
    s_cmp_eq_u32 s52, s53
    s_cselect_b32 s63, s72, s52
    s_add_u32 s52, s63, 4096
    s_cmp_eq_u32 s52, s53
    s_cselect_b32 s64, s72, s52
    s_add_u32 s52, s64, 4096
    s_cmp_eq_u32 s52, s53
    s_cselect_b32 s65, s72, s52
    s_add_u32 s52, s65, 4096
    s_cmp_eq_u32 s52, s53
    s_cselect_b32 s66, s72, s52
    s_add_u32 s52, s66, 4096
    s_cmp_eq_u32 s52, s53
    s_cselect_b32 s67, s72, s52
    s_sub_u32 s52, s65, s72
    s_lshl_b32 s52, s52, 5
    s_min_u32 s45, s52, s77
    s_sub_u32 s52, s66, s72
    s_lshl_b32 s52, s52, 5
    s_min_u32 s46, s52, s77
    s_sub_u32 s52, s67, s72
    s_lshl_b32 s52, s52, 5
    s_min_u32 s50, s52, s77
    s_waitcnt vmcnt(1) lgkmcnt(0)
    s_barrier
    s_barrier
    v_readfirstlane_b32 s52, v246
    s_nop 1
    s_cmp_lg_u32 s52, 0
    s_nop 1
    s_cbranch_scc1 L_ig_okF
L_igF:
    s_sleep 2
    s_buffer_load_dword s52, s[36:39], 0 glc
    s_waitcnt lgkmcnt(0)
    s_cmp_eq_u32 s52, 0
    s_cbranch_scc1 L_igF
L_ig_okF:
    s_branch L_gg
L_fn7:
    s_add_u32 s52, s75, 2
    s_cmp_ge_u32 s52, 11
    s_cselect_b32 s53, 11, 0
    s_sub_u32 s52, s52, s53
    s_lshl_b32 s52, s52, 17
    s_min_u32 s52, s52, s77
    s_add_u32 m0, s73, 114688
    s_nop 0
    buffer_load_dwordx4 v247, s[16:19], s52 offen lds
    s_add_u32 s52, s52, 8192
    s_add_u32 m0, s73, 115712
    s_nop 0
    buffer_load_dwordx4 v247, s[16:19], s52 offen lds
    s_add_u32 s52, s75, 4
    s_cmp_ge_u32 s52, 11
    s_cselect_b32 s53, 11, 0
    s_sub_u32 s52, s52, s53
    s_lshl_b32 s52, s52, 17
    s_min_u32 s52, s52, s77
    s_add_u32 m0, s73, 16384
    s_nop 0
    buffer_load_dwordx4 v247, s[16:19], s52 offen lds
    s_add_u32 s52, s52, 8192
    s_add_u32 m0, s73, 17408
    s_nop 0
    buffer_load_dwordx4 v247, s[16:19], s52 offen lds
    s_waitcnt vmcnt(4) lgkmcnt(0)
    s_cmp_lg_u32 s3, 0
    s_cbranch_scc1 L_nopubF
    v_lshlrev_b32 v11, 11, v2
    v_mov_b32 v10, 1
    s_mov_b64 exec, 1
    s_nop 0
L_init_pollF:
    v_readfirstlane_b32 s52, v246
    s_nop 1
    s_cmp_lg_u32 s52, 0
    s_nop 1
    s_cbranch_scc1 L_init_okF
    buffer_load_dword v246, v9, s[36:39], 0 offen sc1
    s_waitcnt vmcnt(0)
    s_branch L_init_pollF
L_init_okF:
    s_lshl_b32 s52, s43, 8
    s_add_u32 s52, s52, 12599296
    s_mov_b64 exec, 1
    s_barrier
    buffer_atomic_add v10, v11, s[20:23], s52 offen sc1
    s_mov_b64 exec, -1
    s_nop 0
    s_branch L_pubdF
L_nopubF:
    s_barrier
L_pubdF:
    s_barrier
    s_add_u32 s52, s75, 5
    s_cmp_ge_u32 s52, 11
    s_cselect_b32 s53, 11, 0
    s_sub_u32 s52, s52, s53
    s_lshl_b32 s52, s52, 17
    s_min_u32 s52, s52, s77
    s_add_u32 m0, s73, 32768
    s_nop 0
    buffer_load_dwordx4 v247, s[16:19], s52 offen lds
    s_add_u32 s52, s52, 8192
    s_add_u32 m0, s73, 33792
    s_nop 0
    buffer_load_dwordx4 v247, s[16:19], s52 offen lds
    s_add_u32 s52, s75, 6
    s_cmp_ge_u32 s52, 11
    s_cselect_b32 s53, 11, 0
    s_sub_u32 s52, s52, s53
    s_lshl_b32 s52, s52, 17
    s_min_u32 s52, s52, s77
    s_add_u32 m0, s73, 49152
    s_nop 0
    buffer_load_dwordx4 v247, s[16:19], s52 offen lds
    s_add_u32 s52, s52, 8192
    s_add_u32 m0, s73, 50176
    s_nop 0
    buffer_load_dwordx4 v247, s[16:19], s52 offen lds
    s_add_u32 s52, s75, 7
    s_cmp_ge_u32 s52, 11
    s_cselect_b32 s53, 11, 0
    s_sub_u32 s52, s52, s53
    s_lshl_b32 s52, s52, 17
    s_min_u32 s52, s52, s77
    s_add_u32 m0, s73, 65536
    s_nop 0
    buffer_load_dwordx4 v247, s[16:19], s52 offen lds
    s_add_u32 s52, s52, 8192
    s_add_u32 m0, s73, 66560
    s_nop 0
    buffer_load_dwordx4 v247, s[16:19], s52 offen lds
    s_add_u32 s52, s75, 3
    s_cmp_ge_u32 s52, 11
    s_cselect_b32 s53, 11, 0
    s_sub_u32 s52, s52, s53
    s_lshl_b32 s52, s52, 17
    s_min_u32 s52, s52, s77
    s_add_u32 m0, s73, 131072
    s_nop 0
    buffer_load_dwordx4 v247, s[16:19], s52 offen lds
    s_add_u32 s52, s52, 8192
    s_add_u32 m0, s73, 132096
    s_nop 0
    buffer_load_dwordx4 v247, s[16:19], s52 offen lds
    buffer_load_dwordx4 v[232:235], v253, s[8:11], 0 offen
    s_branch L_fcm
L_fh:
    s_cmp_eq_u32 s3, 6
    s_cselect_b32 s52, 1, -2
    s_lshl_b32 s40, s52, 11
    s_add_u32 s40, s40, s73
    s_lshl_b32 s52, s52, 14
    v_add_u32 v245, s52, v247
    s_add_u32 s52, s75, 2
    s_cmp_ge_u32 s52, 11
    s_cselect_b32 s53, 11, 0
    s_sub_u32 s52, s52, s53
    s_lshl_b32 s52, s52, 17
    s_min_u32 s52, s52, s77
    s_add_u32 m0, s73, 114688
    s_nop 0
    buffer_load_dwordx4 v247, s[16:19], s52 offen lds
    s_add_u32 m0, s40, 114688
    s_nop 0
    buffer_load_dwordx4 v245, s[16:19], s52 offen lds
    s_add_u32 s52, s52, 8192
    s_add_u32 m0, s73, 115712
    s_nop 0
    buffer_load_dwordx4 v247, s[16:19], s52 offen lds
    s_add_u32 m0, s40, 115712
    s_nop 0
    buffer_load_dwordx4 v245, s[16:19], s52 offen lds
    s_add_u32 s52, s75, 4
    s_cmp_ge_u32 s52, 11
    s_cselect_b32 s53, 11, 0
    s_sub_u32 s52, s52, s53
    s_lshl_b32 s52, s52, 17
    s_min_u32 s52, s52, s77
    s_add_u32 m0, s73, 16384
    s_nop 0
    buffer_load_dwordx4 v247, s[16:19], s52 offen lds
    s_add_u32 m0, s40, 16384
    s_nop 0
    buffer_load_dwordx4 v245, s[16:19], s52 offen lds
    s_add_u32 s52, s52, 8192
    s_add_u32 m0, s73, 17408
    s_nop 0
    buffer_load_dwordx4 v247, s[16:19], s52 offen lds
    s_add_u32 m0, s40, 17408
    s_nop 0
    buffer_load_dwordx4 v245, s[16:19], s52 offen lds
    s_waitcnt vmcnt(8) lgkmcnt(0)
    s_barrier
    s_barrier
    s_add_u32 s52, s75, 5
    s_cmp_ge_u32 s52, 11
    s_cselect_b32 s53, 11, 0
    s_sub_u32 s52, s52, s53
    s_lshl_b32 s52, s52, 17
    s_min_u32 s52, s52, s77
    s_add_u32 m0, s73, 32768
    s_nop 0
    buffer_load_dwordx4 v247, s[16:19], s52 offen lds
    s_add_u32 m0, s40, 32768
    s_nop 0
    buffer_load_dwordx4 v245, s[16:19], s52 offen lds
    s_add_u32 s52, s52, 8192
    s_add_u32 m0, s73, 33792
    s_nop 0
    buffer_load_dwordx4 v247, s[16:19], s52 offen lds
    s_add_u32 m0, s40, 33792
    s_nop 0
    buffer_load_dwordx4 v245, s[16:19], s52 offen lds
    s_add_u32 s52, s75, 6
    s_cmp_ge_u32 s52, 11
    s_cselect_b32 s53, 11, 0
    s_sub_u32 s52, s52, s53
    s_lshl_b32 s52, s52, 17
    s_min_u32 s52, s52, s77
    s_add_u32 m0, s73, 49152
    s_nop 0
    buffer_load_dwordx4 v247, s[16:19], s52 offen lds
    s_add_u32 m0, s40, 49152
    s_nop 0
    buffer_load_dwordx4 v245, s[16:19], s52 offen lds
    s_add_u32 s52, s52, 8192
    s_add_u32 m0, s73, 50176
    s_nop 0
    buffer_load_dwordx4 v247, s[16:19], s52 offen lds
    s_add_u32 m0, s40, 50176
    s_nop 0
    buffer_load_dwordx4 v245, s[16:19], s52 offen lds
    s_add_u32 s52, s75, 7
    s_cmp_ge_u32 s52, 11
    s_cselect_b32 s53, 11, 0
    s_sub_u32 s52, s52, s53
    s_lshl_b32 s52, s52, 17
    s_min_u32 s52, s52, s77
    s_add_u32 m0, s73, 65536
    s_nop 0
    buffer_load_dwordx4 v247, s[16:19], s52 offen lds
    s_add_u32 m0, s40, 65536
    s_nop 0
    buffer_load_dwordx4 v245, s[16:19], s52 offen lds
    s_add_u32 s52, s52, 8192
    s_add_u32 m0, s73, 66560
    s_nop 0
    buffer_load_dwordx4 v247, s[16:19], s52 offen lds
    s_add_u32 m0, s40, 66560
    s_nop 0
    buffer_load_dwordx4 v245, s[16:19], s52 offen lds
    s_add_u32 s52, s75, 3
    s_cmp_ge_u32 s52, 11
    s_cselect_b32 s53, 11, 0
    s_sub_u32 s52, s52, s53
    s_lshl_b32 s52, s52, 17
    s_min_u32 s52, s52, s77
    s_add_u32 m0, s73, 131072
    s_nop 0
    buffer_load_dwordx4 v247, s[16:19], s52 offen lds
    s_add_u32 m0, s40, 131072
    s_nop 0
    buffer_load_dwordx4 v245, s[16:19], s52 offen lds
    s_add_u32 s52, s52, 8192
    s_add_u32 m0, s73, 132096
    s_nop 0
    buffer_load_dwordx4 v247, s[16:19], s52 offen lds
    s_add_u32 m0, s40, 132096
    s_nop 0
    buffer_load_dwordx4 v245, s[16:19], s52 offen lds
    buffer_load_dwordx4 v[232:235], v253, s[8:11], 0 offen
L_fcm:
    v_lshl_add_u32 v10, v3, 6, s70
    v_lshlrev_b32 v11, 2, v4
    v_mul_u32_u24 v11, v10, v11
    v_and_b32 v11, 2047, v11
    v_cvt_f32_u32 v11, v11
    v_cvt_f32_u32 v10, v10
    v_mul_f32 v11, 0x3a000000, v11
    v_mul_f32 v10, 0x3a000000, v10
    v_cos_f32 v48, v11
    v_sin_f32 v56, v11
    v_fmamk_f32 v12, v10, 0x3f800000, v11
    v_fract_f32 v12, v12
    v_cos_f32 v49, v12
    v_sin_f32 v57, v12
    v_fmamk_f32 v12, v10, 0x40000000, v11
    v_fract_f32 v12, v12
    v_cos_f32 v50, v12
    v_sin_f32 v58, v12
    v_fmamk_f32 v12, v10, 0x40400000, v11
    v_fract_f32 v12, v12
    v_cos_f32 v51, v12
    v_sin_f32 v59, v12
    v_fmamk_f32 v12, v10, 0x41800000, v11
    v_fract_f32 v12, v12
    v_cos_f32 v52, v12
    v_sin_f32 v60, v12
    v_fmamk_f32 v12, v10, 0x41880000, v11
    v_fract_f32 v12, v12
    v_cos_f32 v53, v12
    v_sin_f32 v61, v12
    v_fmamk_f32 v12, v10, 0x41900000, v11
    v_fract_f32 v12, v12
    v_cos_f32 v54, v12
    v_sin_f32 v62, v12
    v_fmamk_f32 v12, v10, 0x41980000, v11
    v_fract_f32 v12, v12
    v_cos_f32 v55, v12
    v_sin_f32 v63, v12
    v_cvt_pk_bf16_f32 v208, v48, v49
    v_cvt_pk_bf16_f32 v212, -v56, -v57
    v_cvt_pk_bf16_f32 v209, v50, v51
    v_cvt_pk_bf16_f32 v213, -v58, -v59
    v_cvt_pk_bf16_f32 v210, v52, v53
    v_cvt_pk_bf16_f32 v214, -v60, -v61
    v_cvt_pk_bf16_f32 v211, v54, v55
    v_cvt_pk_bf16_f32 v215, -v62, -v63
    v_xor_b32 v216, 0x80000000, v208
    v_xor_b32 v217, 0x80000000, v209
    v_xor_b32 v218, 0x80000000, v210
    v_xor_b32 v219, 0x80000000, v211
    v_xor_b32 v220, 0x80000000, v212
    v_xor_b32 v221, 0x80000000, v213
    v_xor_b32 v222, 0x80000000, v214
    v_xor_b32 v223, 0x80000000, v215
    s_add_u32 s52, s75, 4
    s_cmp_ge_u32 s52, 11
    s_cselect_b32 s53, 11, 0
    s_sub_u32 s52, s52, s53
    s_lshl_b32 s52, s52, 12
    s_add_u32 s61, s52, s72
    s_add_u32 s53, s72, 45056
    s_add_u32 s52, s61, 4096
    s_cmp_eq_u32 s52, s53
    s_cselect_b32 s62, s72, s52
    s_add_u32 s52, s62, 4096
    s_cmp_eq_u32 s52, s53
    s_cselect_b32 s63, s72, s52
    s_add_u32 s52, s63, 4096
    s_cmp_eq_u32 s52, s53
    s_cselect_b32 s64, s72, s52
    s_add_u32 s52, s64, 4096
    s_cmp_eq_u32 s52, s53
    s_cselect_b32 s65, s72, s52
    s_add_u32 s52, s65, 4096
    s_cmp_eq_u32 s52, s53
    s_cselect_b32 s66, s72, s52
    s_add_u32 s52, s66, 4096
    s_cmp_eq_u32 s52, s53
    s_cselect_b32 s67, s72, s52
    s_sub_u32 s52, s65, s72
    s_lshl_b32 s52, s52, 5
    s_min_u32 s45, s52, s77
    s_sub_u32 s52, s66, s72
    s_lshl_b32 s52, s52, 5
    s_min_u32 s46, s52, s77
    s_sub_u32 s52, s67, s72
    s_lshl_b32 s52, s52, 5
    s_min_u32 s50, s52, s77
L_gg0:
    s_cmp_eq_u32 s7, 0
    s_cbranch_scc1 L_hw
L_gg:
    s_lshl_b32 s52, s69, 6
    s_lshl_b32 s53, s7, 5
    s_add_u32 s52, s52, s53
    s_add_u32 s52, s52, s71
    v_and_b32 v10, 12, v3
    v_and_b32 v11, 2, v3
    v_lshl_add_u32 v10, v11, 3, v10
    v_and_b32 v11, 1, v3
    v_lshl_add_u32 v10, v11, 1, v10
    v_add_u32 v10, s52, v10
    v_lshlrev_b32 v11, 2, v4
    v_mul_u32_u24 v11, v10, v11
    v_and_b32 v11, 511, v11
    v_lshlrev_b32 v12, 4, v10
    v_and_b32 v12, 511, v12
    v_cvt_f32_u32 v10, v10
    v_cvt_f32_u32 v11, v11
    v_cvt_f32_u32 v12, v12
    v_mul_f32 v10, 0x3b000000, v10
    v_mul_f32 v11, 0x3b000000, v11
    v_mul_f32 v12, 0x3b000000, v12
    v_cos_f32 v168, v11
    v_sin_f32 v169, v11
    v_cos_f32 v170, v10
    v_sin_f32 v171, v10
    v_cos_f32 v172, v12
    v_sin_f32 v173, v12
    s_lshl_b32 s52, s71, 31
    s_xor_b32 s52, s52, 0xb638aa3b
    v_mul_f32 v168, s52, v168
    v_mul_f32 v169, s52, v169
    v_cmp_eq_u32 vcc, 0, v4
    s_nop 1
    v_cndmask_b32 v174, 1.0, 0.5, vcc
    v_mul_f32 v8, v168, v170
    v_mul_f32 v13, v169, v170
    v_mul_f32 v175, v168, v172
    v_mul_f32 v12, v169, v172
    v_fma_f32 v8, -v169, v171, v8
    v_fmac_f32 v13, v168, v171
    v_fma_f32 v175, -v169, v173, v175
    v_fmac_f32 v12, v168, v173
    v_mul_f32 v14, v8, v170
    v_mul_f32 v15, v13, v170
    v_fma_f32 v14, -v13, v171, v14
    v_fmac_f32 v15, v8, v171
    v_mul_f32 v10, v14, v170
    v_mul_f32 v11, v15, v170
    v_fma_f32 v10, -v15, v171, v10
    v_fmac_f32 v11, v14, v171
    v_mul_f32 v168, v168, v174
    v_cvt_pk_bf16_f32 v16, v168, v8
    v_cvt_pk_bf16_f32 v17, v14, v10
    v_cvt_pk_bf16_f32 v18, -v169, -v13
    v_cvt_pk_bf16_f32 v19, -v15, -v11
    v_mul_f32 v8, v175, v170
    v_mul_f32 v13, v12, v170
    v_mul_f32 v168, v175, v172
    v_mul_f32 v169, v12, v172
    v_fma_f32 v8, -v12, v171, v8
    v_fmac_f32 v13, v175, v171
    v_fma_f32 v168, -v12, v173, v168
    v_fmac_f32 v169, v175, v173
    v_mul_f32 v14, v8, v170
    v_mul_f32 v15, v13, v170
    v_fma_f32 v14, -v13, v171, v14
    v_fmac_f32 v15, v8, v171
    v_mul_f32 v10, v14, v170
    v_mul_f32 v11, v15, v170
    v_fma_f32 v10, -v15, v171, v10
    v_fmac_f32 v11, v14, v171
    v_cvt_pk_bf16_f32 v20, v175, v8
    v_cvt_pk_bf16_f32 v21, v14, v10
    v_cvt_pk_bf16_f32 v22, -v12, -v13
    v_cvt_pk_bf16_f32 v23, -v15, -v11
    v_mul_f32 v8, v168, v170
    v_mul_f32 v13, v169, v170
    v_mul_f32 v175, v168, v172
    v_mul_f32 v12, v169, v172
    v_fma_f32 v8, -v169, v171, v8
    v_fmac_f32 v13, v168, v171
    v_fma_f32 v175, -v169, v173, v175
    v_fmac_f32 v12, v168, v173
    v_mul_f32 v14, v8, v170
    v_mul_f32 v15, v13, v170
    v_fma_f32 v14, -v13, v171, v14
    v_fmac_f32 v15, v8, v171
    v_mul_f32 v10, v14, v170
    v_mul_f32 v11, v15, v170
    v_fma_f32 v10, -v15, v171, v10
    v_fmac_f32 v11, v14, v171
    v_cvt_pk_bf16_f32 v24, v168, v8
    v_cvt_pk_bf16_f32 v25, v14, v10
    v_cvt_pk_bf16_f32 v26, -v169, -v13
    v_cvt_pk_bf16_f32 v27, -v15, -v11
    v_mul_f32 v8, v175, v170
    v_mul_f32 v13, v12, v170
    v_mul_f32 v168, v175, v172
    v_mul_f32 v169, v12, v172
    v_fma_f32 v8, -v12, v171, v8
    v_fmac_f32 v13, v175, v171
    v_fma_f32 v168, -v12, v173, v168
    v_fmac_f32 v169, v175, v173
    v_mul_f32 v14, v8, v170
    v_mul_f32 v15, v13, v170
    v_fma_f32 v14, -v13, v171, v14
    v_fmac_f32 v15, v8, v171
    v_mul_f32 v10, v14, v170
    v_mul_f32 v11, v15, v170
    v_fma_f32 v10, -v15, v171, v10
    v_fmac_f32 v11, v14, v171
    v_cvt_pk_bf16_f32 v28, v175, v8
    v_cvt_pk_bf16_f32 v29, v14, v10
    v_cvt_pk_bf16_f32 v30, -v12, -v13
    v_cvt_pk_bf16_f32 v31, -v15, -v11
    v_mul_f32 v8, v168, v170
    v_mul_f32 v13, v169, v170
    v_mul_f32 v175, v168, v172
    v_mul_f32 v12, v169, v172
    v_fma_f32 v8, -v169, v171, v8
    v_fmac_f32 v13, v168, v171
    v_fma_f32 v175, -v169, v173, v175
    v_fmac_f32 v12, v168, v173
    v_mul_f32 v14, v8, v170
    v_mul_f32 v15, v13, v170
    v_fma_f32 v14, -v13, v171, v14
    v_fmac_f32 v15, v8, v171
    v_mul_f32 v10, v14, v170
    v_mul_f32 v11, v15, v170
    v_fma_f32 v10, -v15, v171, v10
    v_fmac_f32 v11, v14, v171
    v_cvt_pk_bf16_f32 v32, v168, v8
    v_cvt_pk_bf16_f32 v33, v14, v10
    v_cvt_pk_bf16_f32 v34, -v169, -v13
    v_cvt_pk_bf16_f32 v35, -v15, -v11
    v_mul_f32 v8, v175, v170
    v_mul_f32 v13, v12, v170
    v_mul_f32 v168, v175, v172
    v_mul_f32 v169, v12, v172
    v_fma_f32 v8, -v12, v171, v8
    v_fmac_f32 v13, v175, v171
    v_fma_f32 v168, -v12, v173, v168
    v_fmac_f32 v169, v175, v173
    v_mul_f32 v14, v8, v170
    v_mul_f32 v15, v13, v170
    v_fma_f32 v14, -v13, v171, v14
    v_fmac_f32 v15, v8, v171
    v_mul_f32 v10, v14, v170
    v_mul_f32 v11, v15, v170
    v_fma_f32 v10, -v15, v171, v10
    v_fmac_f32 v11, v14, v171
    v_cvt_pk_bf16_f32 v36, v175, v8
    v_cvt_pk_bf16_f32 v37, v14, v10
    v_cvt_pk_bf16_f32 v38, -v12, -v13
    v_cvt_pk_bf16_f32 v39, -v15, -v11
    v_mul_f32 v8, v168, v170
    v_mul_f32 v13, v169, v170
    v_mul_f32 v175, v168, v172
    v_mul_f32 v12, v169, v172
    v_fma_f32 v8, -v169, v171, v8
    v_fmac_f32 v13, v168, v171
    v_fma_f32 v175, -v169, v173, v175
    v_fmac_f32 v12, v168, v173
    v_mul_f32 v14, v8, v170
    v_mul_f32 v15, v13, v170
    v_fma_f32 v14, -v13, v171, v14
    v_fmac_f32 v15, v8, v171
    v_mul_f32 v10, v14, v170
    v_mul_f32 v11, v15, v170
    v_fma_f32 v10, -v15, v171, v10
    v_fmac_f32 v11, v14, v171
    v_cvt_pk_bf16_f32 v40, v168, v8
    v_cvt_pk_bf16_f32 v41, v14, v10
    v_cvt_pk_bf16_f32 v42, -v169, -v13
    v_cvt_pk_bf16_f32 v43, -v15, -v11
    v_mul_f32 v8, v175, v170
    v_mul_f32 v13, v12, v170
    v_fma_f32 v8, -v12, v171, v8
    v_fmac_f32 v13, v175, v171
    v_mul_f32 v14, v8, v170
    v_mul_f32 v15, v13, v170
    v_fma_f32 v14, -v13, v171, v14
    v_fmac_f32 v15, v8, v171
    v_mul_f32 v10, v14, v170
    v_mul_f32 v11, v15, v170
    v_fma_f32 v10, -v15, v171, v10
    v_fmac_f32 v11, v14, v171
    v_cvt_pk_bf16_f32 v44, v175, v8
    v_cvt_pk_bf16_f32 v45, v14, v10
    v_cvt_pk_bf16_f32 v46, -v12, -v13
    v_cvt_pk_bf16_f32 v47, -v15, -v11
    s_cmp_lg_u32 s3, 7
    s_nop 0
    s_cbranch_scc1 L_hwX
L_ph:
    s_lshr_b32 s52, s68, 1
    s_lshl_b32 s52, s52, 8
    s_add_u32 s55, s52, 12599296
L_pollH:
    s_buffer_load_dword s52, s[20:23], s55 glc
    s_waitcnt lgkmcnt(0)
    s_cmp_lt_u32 s52, 11
    s_cbranch_scc1 L_pollH
    v_mov_b32 v10, 149504
    v_mov_b32 v11, 1
    ds_write_b32 v10, v11
    s_nop 0
L_hwX:
L_hw:
    v_mov_b32 v10, 149504
    s_nop 1
L_spinH:
    ds_read_b32 v11, v10 offset:0
    s_waitcnt lgkmcnt(0)
    v_readfirstlane_b32 s52, v11
    s_nop 1
    s_cmp_lg_u32 s52, 0
    s_nop 1
    s_cbranch_scc1 L_spinH_ok
    s_sleep 1
    s_branch L_spinH
L_spinH_ok:
    s_cmp_lg_u32 s7, 0
    s_cbranch_scc1 L_ffn1
    s_lshl_b32 s52, s75, 12
    s_add_u32 s52, s52, s72
    s_add_u32 s53, s72, 45056
    buffer_load_dwordx4 v[64:67], v248, s[20:23], s52 offen sc1
    buffer_load_dwordx4 v[68:71], v249, s[20:23], s52 offen sc1
    s_add_u32 s52, s52, 4096
    s_cmp_eq_u32 s52, s53
    s_cselect_b32 s52, s72, s52
    buffer_load_dwordx4 v[72:75], v248, s[20:23], s52 offen sc1
    buffer_load_dwordx4 v[76:79], v249, s[20:23], s52 offen sc1
    s_add_u32 s52, s52, 4096
    s_cmp_eq_u32 s52, s53
    s_cselect_b32 s52, s72, s52
    buffer_load_dwordx4 v[80:83], v248, s[20:23], s52 offen sc1
    buffer_load_dwordx4 v[84:87], v249, s[20:23], s52 offen sc1
    s_add_u32 s52, s52, 4096
    s_cmp_eq_u32 s52, s53
    s_cselect_b32 s52, s72, s52
    buffer_load_dwordx4 v[88:91], v248, s[20:23], s52 offen sc1
    buffer_load_dwordx4 v[92:95], v249, s[20:23], s52 offen sc1
    s_cmp_eq_u32 s48, 0
    s_cbranch_scc1 L_nod
    s_mov_b32 s54, s52
    s_mov_b32 s55, s53
    s_and_b32 s52, s5, 7
    s_lshl_b32 s52, s52, 8
    s_add_u32 s52, s52, 12603392
    v_mov_b32 v10, 149504
    v_mov_b32 v11, 1
    v_lshlrev_b32 v12, 11, v2
    s_waitcnt vmcnt(8)
    s_mov_b64 exec, 1
    ds_add_rtn_u32 v10, v10, v11 offset:8
    s_waitcnt lgkmcnt(0)
    v_readfirstlane_b32 s53, v10
    s_nop 1
    s_add_u32 s53, s53, 1
    s_cmp_lg_u32 s53, s42
    s_nop 0
    s_cbranch_scc1 L_nod1b
    s_mov_b64 exec, 0xff
    buffer_atomic_add v11, v12, s[20:23], s52 offen sc1
    s_nop 1
L_nod1b:
    s_mov_b64 exec, -1
    s_mov_b32 s52, s54
    s_mov_b32 s53, s55
    s_mov_b32 s48, 0
L_nod:
    s_waitcnt vmcnt(6)
    s_waitcnt lgkmcnt(0)
    s_barrier
    ds_read_b64_tr_b16 v[176:177], v228 offset:16384
    ds_read_b64_tr_b16 v[178:179], v228 offset:18432
    ds_read_b64_tr_b16 v[180:181], v229 offset:16384
    ds_read_b64_tr_b16 v[182:183], v229 offset:18432
    ds_read_b64_tr_b16 v[184:185], v230 offset:16384
    ds_read_b64_tr_b16 v[186:187], v230 offset:18432
    ds_read_b64_tr_b16 v[188:189], v231 offset:16384
    ds_read_b64_tr_b16 v[190:191], v231 offset:18432
    ds_read_b64_tr_b16 v[192:193], v228 offset:32768
    ds_read_b64_tr_b16 v[194:195], v228 offset:34816
    ds_read_b64_tr_b16 v[196:197], v229 offset:32768
    ds_read_b64_tr_b16 v[198:199], v229 offset:34816
    ds_read_b64_tr_b16 v[200:201], v230 offset:32768
    ds_read_b64_tr_b16 v[202:203], v230 offset:34816
    ds_read_b64_tr_b16 v[204:205], v231 offset:32768
    ds_read_b64_tr_b16 v[206:207], v231 offset:34816
    s_add_u32 m0, s73, 0
    s_nop 0
    buffer_load_dwordx4 v247, s[16:19], s45 offen lds
    s_add_u32 s45, s45, 8192
    s_add_u32 m0, s73, 1024
    s_nop 0
    buffer_load_dwordx4 v247, s[16:19], s45 offen lds
    s_waitcnt lgkmcnt(8)
    v_mfma_f32_16x16x32_bf16 v[152:155], v[176:179], v[64:67], 0
    ds_read_b64_tr_b16 v[136:137], v228 offset:49152
    s_lshl_b32 s40, s69, 6
    s_lshl_b32 s41, s7, 5
    s_add_u32 s40, s40, s41
    v_mfma_f32_16x16x32_bf16 v[48:51], v[176:179], v[68:71], 0
    ds_read_b64_tr_b16 v[138:139], v228 offset:51200
    s_add_u32 s40, s40, s71
    v_and_b32 v10, 12, v3
    v_and_b32 v11, 2, v3
    v_mfma_f32_16x16x32_bf16 v[156:159], v[180:183], v[64:67], 0
    ds_read_b64_tr_b16 v[140:141], v229 offset:49152
    v_lshl_add_u32 v10, v11, 3, v10
    v_and_b32 v11, 1, v3
    v_lshl_add_u32 v10, v11, 1, v10
    v_mfma_f32_16x16x32_bf16 v[52:55], v[180:183], v[68:71], 0
    ds_read_b64_tr_b16 v[142:143], v229 offset:51200
    v_add_u32 v10, s40, v10
    v_lshlrev_b32 v11, 2, v4
    v_mul_u32_u24 v11, v10, v11
    v_mfma_f32_16x16x32_bf16 v[160:163], v[184:187], v[64:67], 0
    ds_read_b64_tr_b16 v[144:145], v230 offset:49152
    v_and_b32 v11, 511, v11
    v_lshlrev_b32 v12, 4, v10
    v_and_b32 v12, 511, v12
    buffer_load_dwordx4 v[96:99], v248, s[20:23], s61 offen sc1
    buffer_load_dwordx4 v[100:103], v249, s[20:23], s61 offen sc1
    v_mfma_f32_16x16x32_bf16 v[56:59], v[184:187], v[68:71], 0
    ds_read_b64_tr_b16 v[146:147], v230 offset:51200
    v_cvt_f32_u32 v10, v10
    v_cvt_f32_u32 v11, v11
    v_cvt_f32_u32 v12, v12
    v_mfma_f32_16x16x32_bf16 v[164:167], v[188:191], v[64:67], 0
    ds_read_b64_tr_b16 v[148:149], v231 offset:49152
    v_mul_f32 v10, 0x3b000000, v10
    v_mul_f32 v11, 0x3b000000, v11
    v_mul_f32 v12, 0x3b000000, v12
    v_mfma_f32_16x16x32_bf16 v[60:63], v[188:191], v[68:71], 0
    ds_read_b64_tr_b16 v[150:151], v231 offset:51200
    v_cos_f32 v168, v11
    v_sin_f32 v169, v11
    s_waitcnt lgkmcnt(8)
    s_waitcnt vmcnt(8)
    v_mfma_f32_16x16x32_bf16 v[152:155], v[192:195], v[72:75], v[152:155]
    ds_read_b64_tr_b16 v[176:177], v240 offset:0
    v_cos_f32 v170, v10
    v_sin_f32 v171, v10
    v_cos_f32 v172, v12
    v_mfma_f32_16x16x32_bf16 v[48:51], v[192:195], v[76:79], v[48:51]
    ds_read_b64_tr_b16 v[178:179], v240 offset:2048
    v_sin_f32 v173, v12
    s_lshl_b32 s40, s71, 31
    s_xor_b32 s40, s40, 0xb638aa3b
    v_mfma_f32_16x16x32_bf16 v[156:159], v[196:199], v[72:75], v[156:159]
    ds_read_b64_tr_b16 v[180:181], v241 offset:0
    v_mul_f32 v168, s40, v168
    v_mul_f32 v169, s40, v169
    v_cmp_eq_u32 vcc, 0, v4
    v_mfma_f32_16x16x32_bf16 v[52:55], v[196:199], v[76:79], v[52:55]
    ds_read_b64_tr_b16 v[182:183], v241 offset:2048
    v_cndmask_b32 v174, 1.0, 0.5, vcc
    v_mul_f32 v8, v168, v170
    v_mul_f32 v13, v169, v170
    v_mfma_f32_16x16x32_bf16 v[160:163], v[200:203], v[72:75], v[160:163]
    ds_read_b64_tr_b16 v[184:185], v242 offset:0
    v_mul_f32 v175, v168, v172
    v_mul_f32 v12, v169, v172
    v_fma_f32 v8, -v169, v171, v8
    buffer_load_dwordx4 v[104:107], v248, s[20:23], s62 offen sc1
    buffer_load_dwordx4 v[108:111], v249, s[20:23], s62 offen sc1
    v_mfma_f32_16x16x32_bf16 v[56:59], v[200:203], v[76:79], v[56:59]
    ds_read_b64_tr_b16 v[186:187], v242 offset:2048
    v_fmac_f32 v13, v168, v171
    v_fma_f32 v175, -v169, v173, v175
    v_fmac_f32 v12, v168, v173
    v_mfma_f32_16x16x32_bf16 v[164:167], v[204:207], v[72:75], v[164:167]
    ds_read_b64_tr_b16 v[188:189], v243 offset:0
    v_mul_f32 v14, v8, v170
    v_mul_f32 v15, v13, v170
    v_fma_f32 v14, -v13, v171, v14
    v_mfma_f32_16x16x32_bf16 v[60:63], v[204:207], v[76:79], v[60:63]
    ds_read_b64_tr_b16 v[190:191], v243 offset:2048
    v_fmac_f32 v15, v8, v171
    v_mul_f32 v10, v14, v170
    v_mul_f32 v11, v15, v170
    s_waitcnt lgkmcnt(8)
    s_waitcnt vmcnt(8)
    v_mfma_f32_16x16x32_bf16 v[152:155], v[136:139], v[80:83], v[152:155]
    ds_read_b64_tr_b16 v[192:193], v224 offset:16384
    v_fma_f32 v10, -v15, v171, v10
    v_fmac_f32 v11, v14, v171
    v_mul_f32 v168, v168, v174
    v_mfma_f32_16x16x32_bf16 v[48:51], v[136:139], v[84:87], v[48:51]
    ds_read_b64_tr_b16 v[194:195], v224 offset:18432
    v_cvt_pk_bf16_f32 v16, v168, v8
    v_cvt_pk_bf16_f32 v17, v14, v10
    v_cvt_pk_bf16_f32 v18, -v169, -v13
    v_mfma_f32_16x16x32_bf16 v[156:159], v[140:143], v[80:83], v[156:159]
    ds_read_b64_tr_b16 v[196:197], v225 offset:16384
    v_cvt_pk_bf16_f32 v19, -v15, -v11
    v_mul_f32 v8, v175, v170
    v_mul_f32 v13, v12, v170
    v_mfma_f32_16x16x32_bf16 v[52:55], v[140:143], v[84:87], v[52:55]
    ds_read_b64_tr_b16 v[198:199], v225 offset:18432
    v_mul_f32 v168, v175, v172
    v_mul_f32 v169, v12, v172
    v_fma_f32 v8, -v12, v171, v8
    v_mfma_f32_16x16x32_bf16 v[160:163], v[144:147], v[80:83], v[160:163]
    ds_read_b64_tr_b16 v[200:201], v226 offset:16384
    v_fmac_f32 v13, v175, v171
    v_fma_f32 v168, -v12, v173, v168
    v_fmac_f32 v169, v175, v173
    buffer_load_dwordx4 v[112:115], v248, s[20:23], s63 offen sc1
    buffer_load_dwordx4 v[116:119], v249, s[20:23], s63 offen sc1
    v_mfma_f32_16x16x32_bf16 v[56:59], v[144:147], v[84:87], v[56:59]
    ds_read_b64_tr_b16 v[202:203], v226 offset:18432
    v_mul_f32 v14, v8, v170
    v_mul_f32 v15, v13, v170
    v_fma_f32 v14, -v13, v171, v14
    v_mfma_f32_16x16x32_bf16 v[164:167], v[148:151], v[80:83], v[164:167]
    ds_read_b64_tr_b16 v[204:205], v227 offset:16384
    v_fmac_f32 v15, v8, v171
    v_mul_f32 v10, v14, v170
    v_mul_f32 v11, v15, v170
    v_mfma_f32_16x16x32_bf16 v[60:63], v[148:151], v[84:87], v[60:63]
    ds_read_b64_tr_b16 v[206:207], v227 offset:18432
    v_fma_f32 v10, -v15, v171, v10
    v_fmac_f32 v11, v14, v171
    v_cvt_pk_bf16_f32 v20, v175, v8
    s_waitcnt lgkmcnt(8)
    s_waitcnt vmcnt(6)
    s_barrier
    v_mfma_f32_16x16x32_bf16 v[152:155], v[176:179], v[88:91], v[152:155]
    ds_read_b64_tr_b16 v[64:65], v224 offset:32768
    v_cvt_pk_bf16_f32 v21, v14, v10
    v_cvt_pk_bf16_f32 v22, -v12, -v13
    v_cvt_pk_bf16_f32 v23, -v15, -v11
    v_mfma_f32_16x16x32_bf16 v[48:51], v[176:179], v[92:95], v[48:51]
    ds_read_b64_tr_b16 v[66:67], v224 offset:34816
    v_mul_f32 v8, v168, v170
    v_mul_f32 v13, v169, v170
    v_mul_f32 v175, v168, v172
    v_mfma_f32_16x16x32_bf16 v[156:159], v[180:183], v[88:91], v[156:159]
    ds_read_b64_tr_b16 v[68:69], v225 offset:32768
    v_mul_f32 v12, v169, v172
    v_fma_f32 v8, -v169, v171, v8
    v_fmac_f32 v13, v168, v171
    v_mfma_f32_16x16x32_bf16 v[52:55], v[180:183], v[92:95], v[52:55]
    ds_read_b64_tr_b16 v[70:71], v225 offset:34816
    v_fma_f32 v175, -v169, v173, v175
    v_fmac_f32 v12, v168, v173
    v_mul_f32 v14, v8, v170
    v_mfma_f32_16x16x32_bf16 v[160:163], v[184:187], v[88:91], v[160:163]
    ds_read_b64_tr_b16 v[72:73], v226 offset:32768
    v_mul_f32 v15, v13, v170
    v_fma_f32 v14, -v13, v171, v14
    v_fmac_f32 v15, v8, v171
    buffer_load_dwordx4 v[120:123], v248, s[20:23], s64 offen sc1
    buffer_load_dwordx4 v[124:127], v249, s[20:23], s64 offen sc1
    v_mfma_f32_16x16x32_bf16 v[56:59], v[184:187], v[92:95], v[56:59]
    ds_read_b64_tr_b16 v[74:75], v226 offset:34816
    v_mul_f32 v10, v14, v170
    v_mul_f32 v11, v15, v170
    v_fma_f32 v10, -v15, v171, v10
    v_mfma_f32_16x16x32_bf16 v[164:167], v[188:191], v[88:91], v[164:167]
    ds_read_b64_tr_b16 v[76:77], v227 offset:32768
    v_fmac_f32 v11, v14, v171
    v_cvt_pk_bf16_f32 v24, v168, v8
    v_cvt_pk_bf16_f32 v25, v14, v10
    s_add_u32 m0, s73, 81920
    s_nop 0
    buffer_load_dwordx4 v247, s[16:19], s46 offen lds
    s_add_u32 s46, s46, 8192
    s_add_u32 m0, s73, 82944
    s_nop 0
    buffer_load_dwordx4 v247, s[16:19], s46 offen lds
    v_mfma_f32_16x16x32_bf16 v[60:63], v[188:191], v[92:95], v[60:63]
    ds_read_b64_tr_b16 v[78:79], v227 offset:34816
    v_cvt_pk_bf16_f32 v26, -v169, -v13
    v_cvt_pk_bf16_f32 v27, -v15, -v11
    v_mul_f32 v8, v175, v170
    s_waitcnt lgkmcnt(8)
    s_waitcnt vmcnt(8)
    v_mfma_f32_16x16x32_bf16 v[152:155], v[192:195], v[96:99], v[152:155]
    ds_read_b64_tr_b16 v[176:177], v224 offset:49152
    v_mul_f32 v13, v12, v170
    v_mul_f32 v168, v175, v172
    v_mul_f32 v169, v12, v172
    v_mfma_f32_16x16x32_bf16 v[48:51], v[192:195], v[100:103], v[48:51]
    ds_read_b64_tr_b16 v[178:179], v224 offset:51200
    v_fma_f32 v8, -v12, v171, v8
    v_fmac_f32 v13, v175, v171
    v_fma_f32 v168, -v12, v173, v168
    v_mfma_f32_16x16x32_bf16 v[156:159], v[196:199], v[96:99], v[156:159]
    ds_read_b64_tr_b16 v[180:181], v225 offset:49152
    v_fmac_f32 v169, v175, v173
    v_mul_f32 v14, v8, v170
    v_mul_f32 v15, v13, v170
    v_mfma_f32_16x16x32_bf16 v[52:55], v[196:199], v[100:103], v[52:55]
    ds_read_b64_tr_b16 v[182:183], v225 offset:51200
    v_fma_f32 v14, -v13, v171, v14
    v_fmac_f32 v15, v8, v171
    v_mul_f32 v10, v14, v170
    v_mfma_f32_16x16x32_bf16 v[160:163], v[200:203], v[96:99], v[160:163]
    ds_read_b64_tr_b16 v[184:185], v226 offset:49152
    v_mul_f32 v11, v15, v170
    v_fma_f32 v10, -v15, v171, v10
    v_fmac_f32 v11, v14, v171
    buffer_load_dwordx4 v[128:131], v248, s[20:23], s65 offen sc1
    buffer_load_dwordx4 v[132:135], v249, s[20:23], s65 offen sc1
    v_mfma_f32_16x16x32_bf16 v[56:59], v[200:203], v[100:103], v[56:59]
    ds_read_b64_tr_b16 v[186:187], v226 offset:51200
    v_cvt_pk_bf16_f32 v28, v175, v8
    v_cvt_pk_bf16_f32 v29, v14, v10
    v_cvt_pk_bf16_f32 v30, -v12, -v13
    v_mfma_f32_16x16x32_bf16 v[164:167], v[204:207], v[96:99], v[164:167]
    ds_read_b64_tr_b16 v[188:189], v227 offset:49152
    v_cvt_pk_bf16_f32 v31, -v15, -v11
    v_mul_f32 v8, v168, v170
    v_mul_f32 v13, v169, v170
    s_add_u32 m0, s73, 98304
    s_nop 0
    buffer_load_dwordx4 v247, s[16:19], s50 offen lds
    s_add_u32 s50, s50, 8192
    s_add_u32 m0, s73, 99328
    s_nop 0
    buffer_load_dwordx4 v247, s[16:19], s50 offen lds
    v_and_b32 v252, 7, v2
    v_lshlrev_b32 v252, 8, v252
    s_lshl_b32 s64, s4, 11
    s_add_u32 s64, s64, 12603392
    buffer_load_dword v251, v252, s[20:23], s64 offen sc1
    v_mfma_f32_16x16x32_bf16 v[60:63], v[204:207], v[100:103], v[60:63]
    ds_read_b64_tr_b16 v[190:191], v227 offset:51200
    v_mul_f32 v175, v168, v172
    v_mul_f32 v12, v169, v172
    s_waitcnt lgkmcnt(8)
    s_waitcnt vmcnt(11)
    v_mfma_f32_16x16x32_bf16 v[152:155], v[64:67], v[104:107], v[152:155]
    ds_read_b64_tr_b16 v[192:193], v228 offset:0
    v_fma_f32 v8, -v169, v171, v8
    v_fmac_f32 v13, v168, v171
    v_fma_f32 v175, -v169, v173, v175
    v_mfma_f32_16x16x32_bf16 v[48:51], v[64:67], v[108:111], v[48:51]
    ds_read_b64_tr_b16 v[194:195], v228 offset:2048
    v_fmac_f32 v12, v168, v173
    v_mul_f32 v14, v8, v170
    v_mul_f32 v15, v13, v170
    v_mfma_f32_16x16x32_bf16 v[156:159], v[68:71], v[104:107], v[156:159]
    ds_read_b64_tr_b16 v[196:197], v229 offset:0
    v_fma_f32 v14, -v13, v171, v14
    v_fmac_f32 v15, v8, v171
    v_mul_f32 v10, v14, v170
    v_mfma_f32_16x16x32_bf16 v[52:55], v[68:71], v[108:111], v[52:55]
    ds_read_b64_tr_b16 v[198:199], v229 offset:2048
    v_mul_f32 v11, v15, v170
    v_fma_f32 v10, -v15, v171, v10
    v_fmac_f32 v11, v14, v171
    v_mfma_f32_16x16x32_bf16 v[160:163], v[72:75], v[104:107], v[160:163]
    ds_read_b64_tr_b16 v[200:201], v230 offset:0
    v_cvt_pk_bf16_f32 v32, v168, v8
    v_cvt_pk_bf16_f32 v33, v14, v10
    v_cvt_pk_bf16_f32 v34, -v169, -v13
    buffer_load_dwordx4 v[136:139], v248, s[20:23], s66 offen sc1
    buffer_load_dwordx4 v[140:143], v249, s[20:23], s66 offen sc1
    v_mfma_f32_16x16x32_bf16 v[56:59], v[72:75], v[108:111], v[56:59]
    ds_read_b64_tr_b16 v[202:203], v230 offset:2048
    v_cvt_pk_bf16_f32 v35, -v15, -v11
    v_mul_f32 v8, v175, v170
    v_mul_f32 v13, v12, v170
    v_mfma_f32_16x16x32_bf16 v[164:167], v[76:79], v[104:107], v[164:167]
    ds_read_b64_tr_b16 v[204:205], v231 offset:0
    v_mul_f32 v168, v175, v172
    v_mul_f32 v169, v12, v172
    v_fma_f32 v8, -v12, v171, v8
    v_mfma_f32_16x16x32_bf16 v[60:63], v[76:79], v[108:111], v[60:63]
    ds_read_b64_tr_b16 v[206:207], v231 offset:2048
    v_fmac_f32 v13, v175, v171
    v_fma_f32 v168, -v12, v173, v168
    v_fmac_f32 v169, v175, v173
    s_waitcnt lgkmcnt(8)
    s_waitcnt vmcnt(11)
    v_mfma_f32_16x16x32_bf16 v[152:155], v[176:179], v[112:115], v[152:155]
    ds_read_b64_tr_b16 v[64:65], v224 offset:0
    v_mul_f32 v14, v8, v170
    v_mul_f32 v15, v13, v170
    v_fma_f32 v14, -v13, v171, v14
    v_mfma_f32_16x16x32_bf16 v[48:51], v[176:179], v[116:119], v[48:51]
    ds_read_b64_tr_b16 v[66:67], v224 offset:2048
    v_fmac_f32 v15, v8, v171
    v_mul_f32 v10, v14, v170
    v_mul_f32 v11, v15, v170
    v_mfma_f32_16x16x32_bf16 v[156:159], v[180:183], v[112:115], v[156:159]
    ds_read_b64_tr_b16 v[68:69], v225 offset:0
    v_fma_f32 v10, -v15, v171, v10
    v_fmac_f32 v11, v14, v171
    v_cvt_pk_bf16_f32 v36, v175, v8
    v_mfma_f32_16x16x32_bf16 v[52:55], v[180:183], v[116:119], v[52:55]
    ds_read_b64_tr_b16 v[70:71], v225 offset:2048
    v_cvt_pk_bf16_f32 v37, v14, v10
    v_cvt_pk_bf16_f32 v38, -v12, -v13
    v_cvt_pk_bf16_f32 v39, -v15, -v11
    v_mfma_f32_16x16x32_bf16 v[160:163], v[184:187], v[112:115], v[160:163]
    ds_read_b64_tr_b16 v[72:73], v226 offset:0
    v_mul_f32 v8, v168, v170
    v_mul_f32 v13, v169, v170
    v_mul_f32 v175, v168, v172
    buffer_load_dwordx4 v[144:147], v248, s[20:23], s67 offen sc1
    buffer_load_dwordx4 v[148:151], v249, s[20:23], s67 offen sc1
    v_mfma_f32_16x16x32_bf16 v[56:59], v[184:187], v[116:119], v[56:59]
    ds_read_b64_tr_b16 v[74:75], v226 offset:2048
    v_mul_f32 v12, v169, v172
    v_fma_f32 v8, -v169, v171, v8
    v_fmac_f32 v13, v168, v171
    v_mfma_f32_16x16x32_bf16 v[164:167], v[188:191], v[112:115], v[164:167]
    ds_read_b64_tr_b16 v[76:77], v227 offset:0
    v_fma_f32 v175, -v169, v173, v175
    v_fmac_f32 v12, v168, v173
    v_mul_f32 v14, v8, v170
    v_mfma_f32_16x16x32_bf16 v[60:63], v[188:191], v[116:119], v[60:63]
    ds_read_b64_tr_b16 v[78:79], v227 offset:2048
    v_mul_f32 v15, v13, v170
    v_fma_f32 v14, -v13, v171, v14
    v_fmac_f32 v15, v8, v171
    s_waitcnt lgkmcnt(8)
    s_waitcnt vmcnt(5)
    s_barrier
    v_mfma_f32_16x16x32_bf16 v[152:155], v[192:195], v[120:123], v[152:155]
    ds_read_b64_tr_b16 v[176:177], v228 offset:16384
    v_mul_f32 v10, v14, v170
    v_mul_f32 v11, v15, v170
    v_fma_f32 v10, -v15, v171, v10
    v_mfma_f32_16x16x32_bf16 v[48:51], v[192:195], v[124:127], v[48:51]
    ds_read_b64_tr_b16 v[178:179], v228 offset:18432
    v_fmac_f32 v11, v14, v171
    v_cvt_pk_bf16_f32 v40, v168, v8
    v_cvt_pk_bf16_f32 v41, v14, v10
    s_lshl_b32 s53, s3, 10
    s_add_u32 s52, s74, s53
    s_add_u32 m0, s53, 114688
    s_nop 0
    buffer_load_dwordx4 v5, s[20:23], s52 offen sc1 lds
    v_mfma_f32_16x16x32_bf16 v[156:159], v[196:199], v[120:123], v[156:159]
    ds_read_b64_tr_b16 v[180:181], v229 offset:16384
    v_cvt_pk_bf16_f32 v42, -v169, -v13
    v_cvt_pk_bf16_f32 v43, -v15, -v11
    v_mul_f32 v8, v175, v170
    v_mfma_f32_16x16x32_bf16 v[52:55], v[196:199], v[124:127], v[52:55]
    ds_read_b64_tr_b16 v[182:183], v229 offset:18432
    v_mul_f32 v13, v12, v170
    v_fma_f32 v8, -v12, v171, v8
    v_fmac_f32 v13, v175, v171
    v_mfma_f32_16x16x32_bf16 v[160:163], v[200:203], v[120:123], v[160:163]
    ds_read_b64_tr_b16 v[184:185], v230 offset:16384
    v_mul_f32 v14, v8, v170
    v_mul_f32 v15, v13, v170
    v_fma_f32 v14, -v13, v171, v14
    s_add_u32 s52, s52, 8192
    s_add_u32 m0, s53, 122880
    s_nop 0
    buffer_load_dwordx4 v5, s[20:23], s52 offen sc1 lds
    v_mfma_f32_16x16x32_bf16 v[56:59], v[200:203], v[124:127], v[56:59]
    ds_read_b64_tr_b16 v[186:187], v230 offset:18432
    v_fmac_f32 v15, v8, v171
    v_mul_f32 v10, v14, v170
    v_mul_f32 v11, v15, v170
    v_mfma_f32_16x16x32_bf16 v[164:167], v[204:207], v[120:123], v[164:167]
    ds_read_b64_tr_b16 v[188:189], v231 offset:16384
    v_fma_f32 v10, -v15, v171, v10
    v_fmac_f32 v11, v14, v171
    v_cvt_pk_bf16_f32 v44, v175, v8
    s_add_u32 s52, s52, 8192
    s_add_u32 m0, s53, 131072
    s_nop 0
    buffer_load_dwordx4 v5, s[20:23], s52 offen sc1 lds
    v_mfma_f32_16x16x32_bf16 v[60:63], v[204:207], v[124:127], v[60:63]
    ds_read_b64_tr_b16 v[190:191], v231 offset:18432
    v_cvt_pk_bf16_f32 v45, v14, v10
    v_cvt_pk_bf16_f32 v46, -v12, -v13
    v_cvt_pk_bf16_f32 v47, -v15, -v11
    s_nop 3
    s_branch L_ffn2
L_ffn1:
    s_lshl_b32 s52, s75, 12
    s_add_u32 s52, s52, s72
    s_add_u32 s53, s72, 45056
    buffer_load_dwordx4 v[64:67], v248, s[20:23], s52 offen sc1
    buffer_load_dwordx4 v[68:71], v249, s[20:23], s52 offen sc1
    s_add_u32 s52, s52, 4096
    s_cmp_eq_u32 s52, s53
    s_cselect_b32 s52, s72, s52
    buffer_load_dwordx4 v[72:75], v248, s[20:23], s52 offen sc1
    buffer_load_dwordx4 v[76:79], v249, s[20:23], s52 offen sc1
    s_add_u32 s52, s52, 4096
    s_cmp_eq_u32 s52, s53
    s_cselect_b32 s52, s72, s52
    buffer_load_dwordx4 v[80:83], v248, s[20:23], s52 offen sc1
    buffer_load_dwordx4 v[84:87], v249, s[20:23], s52 offen sc1
    s_add_u32 s52, s52, 4096
    s_cmp_eq_u32 s52, s53
    s_cselect_b32 s52, s72, s52
    buffer_load_dwordx4 v[88:91], v248, s[20:23], s52 offen sc1
    buffer_load_dwordx4 v[92:95], v249, s[20:23], s52 offen sc1
    s_waitcnt vmcnt(6)
    s_waitcnt lgkmcnt(0)
    s_barrier
    ds_read_b64_tr_b16 v[176:177], v228 offset:16384
    ds_read_b64_tr_b16 v[178:179], v228 offset:18432
    ds_read_b64_tr_b16 v[180:181], v229 offset:16384
    ds_read_b64_tr_b16 v[182:183], v229 offset:18432
    ds_read_b64_tr_b16 v[184:185], v230 offset:16384
    ds_read_b64_tr_b16 v[186:187], v230 offset:18432
    ds_read_b64_tr_b16 v[188:189], v231 offset:16384
    ds_read_b64_tr_b16 v[190:191], v231 offset:18432
    ds_read_b64_tr_b16 v[192:193], v228 offset:32768
    ds_read_b64_tr_b16 v[194:195], v228 offset:34816
    ds_read_b64_tr_b16 v[196:197], v229 offset:32768
    ds_read_b64_tr_b16 v[198:199], v229 offset:34816
    ds_read_b64_tr_b16 v[200:201], v230 offset:32768
    ds_read_b64_tr_b16 v[202:203], v230 offset:34816
    ds_read_b64_tr_b16 v[204:205], v231 offset:32768
    ds_read_b64_tr_b16 v[206:207], v231 offset:34816
    s_add_u32 m0, s73, 0
    s_nop 0
    buffer_load_dwordx4 v247, s[16:19], s45 offen lds
    s_add_u32 s45, s45, 8192
    s_add_u32 m0, s73, 1024
    s_nop 0
    buffer_load_dwordx4 v247, s[16:19], s45 offen lds
    s_waitcnt lgkmcnt(8)
    v_mfma_f32_16x16x32_bf16 v[152:155], v[176:179], v[64:67], 0
    ds_read_b64_tr_b16 v[136:137], v228 offset:49152
    v_mfma_f32_16x16x32_bf16 v[48:51], v[176:179], v[68:71], 0
    ds_read_b64_tr_b16 v[138:139], v228 offset:51200
    v_mfma_f32_16x16x32_bf16 v[156:159], v[180:183], v[64:67], 0
    ds_read_b64_tr_b16 v[140:141], v229 offset:49152
    v_mfma_f32_16x16x32_bf16 v[52:55], v[180:183], v[68:71], 0
    ds_read_b64_tr_b16 v[142:143], v229 offset:51200
    v_mfma_f32_16x16x32_bf16 v[160:163], v[184:187], v[64:67], 0
    ds_read_b64_tr_b16 v[144:145], v230 offset:49152
    buffer_load_dwordx4 v[96:99], v248, s[20:23], s61 offen sc1
    buffer_load_dwordx4 v[100:103], v249, s[20:23], s61 offen sc1
    v_mfma_f32_16x16x32_bf16 v[56:59], v[184:187], v[68:71], 0
    ds_read_b64_tr_b16 v[146:147], v230 offset:51200
    v_mfma_f32_16x16x32_bf16 v[164:167], v[188:191], v[64:67], 0
    ds_read_b64_tr_b16 v[148:149], v231 offset:49152
    v_mfma_f32_16x16x32_bf16 v[60:63], v[188:191], v[68:71], 0
    ds_read_b64_tr_b16 v[150:151], v231 offset:51200
    s_waitcnt lgkmcnt(8)
    s_waitcnt vmcnt(8)
    v_mfma_f32_16x16x32_bf16 v[152:155], v[192:195], v[72:75], v[152:155]
    ds_read_b64_tr_b16 v[176:177], v240 offset:0
    v_mfma_f32_16x16x32_bf16 v[48:51], v[192:195], v[76:79], v[48:51]
    ds_read_b64_tr_b16 v[178:179], v240 offset:2048
    v_mfma_f32_16x16x32_bf16 v[156:159], v[196:199], v[72:75], v[156:159]
    ds_read_b64_tr_b16 v[180:181], v241 offset:0
    v_mfma_f32_16x16x32_bf16 v[52:55], v[196:199], v[76:79], v[52:55]
    ds_read_b64_tr_b16 v[182:183], v241 offset:2048
    v_mfma_f32_16x16x32_bf16 v[160:163], v[200:203], v[72:75], v[160:163]
    ds_read_b64_tr_b16 v[184:185], v242 offset:0
    buffer_load_dwordx4 v[104:107], v248, s[20:23], s62 offen sc1
    buffer_load_dwordx4 v[108:111], v249, s[20:23], s62 offen sc1
    v_mfma_f32_16x16x32_bf16 v[56:59], v[200:203], v[76:79], v[56:59]
    ds_read_b64_tr_b16 v[186:187], v242 offset:2048
    v_mfma_f32_16x16x32_bf16 v[164:167], v[204:207], v[72:75], v[164:167]
    ds_read_b64_tr_b16 v[188:189], v243 offset:0
    v_mfma_f32_16x16x32_bf16 v[60:63], v[204:207], v[76:79], v[60:63]
    ds_read_b64_tr_b16 v[190:191], v243 offset:2048
    s_waitcnt lgkmcnt(8)
    s_waitcnt vmcnt(8)
    v_mfma_f32_16x16x32_bf16 v[152:155], v[136:139], v[80:83], v[152:155]
    ds_read_b64_tr_b16 v[192:193], v224 offset:16384
    v_mfma_f32_16x16x32_bf16 v[48:51], v[136:139], v[84:87], v[48:51]
    ds_read_b64_tr_b16 v[194:195], v224 offset:18432
    v_mfma_f32_16x16x32_bf16 v[156:159], v[140:143], v[80:83], v[156:159]
    ds_read_b64_tr_b16 v[196:197], v225 offset:16384
    v_mfma_f32_16x16x32_bf16 v[52:55], v[140:143], v[84:87], v[52:55]
    ds_read_b64_tr_b16 v[198:199], v225 offset:18432
    v_mfma_f32_16x16x32_bf16 v[160:163], v[144:147], v[80:83], v[160:163]
    ds_read_b64_tr_b16 v[200:201], v226 offset:16384
    buffer_load_dwordx4 v[112:115], v248, s[20:23], s63 offen sc1
    buffer_load_dwordx4 v[116:119], v249, s[20:23], s63 offen sc1
    v_mfma_f32_16x16x32_bf16 v[56:59], v[144:147], v[84:87], v[56:59]
    ds_read_b64_tr_b16 v[202:203], v226 offset:18432
    v_mfma_f32_16x16x32_bf16 v[164:167], v[148:151], v[80:83], v[164:167]
    ds_read_b64_tr_b16 v[204:205], v227 offset:16384
    v_mfma_f32_16x16x32_bf16 v[60:63], v[148:151], v[84:87], v[60:63]
    ds_read_b64_tr_b16 v[206:207], v227 offset:18432
    s_waitcnt lgkmcnt(8)
    s_waitcnt vmcnt(6)
    s_barrier
    v_mfma_f32_16x16x32_bf16 v[152:155], v[176:179], v[88:91], v[152:155]
    ds_read_b64_tr_b16 v[64:65], v224 offset:32768
    v_mfma_f32_16x16x32_bf16 v[48:51], v[176:179], v[92:95], v[48:51]
    ds_read_b64_tr_b16 v[66:67], v224 offset:34816
    v_mfma_f32_16x16x32_bf16 v[156:159], v[180:183], v[88:91], v[156:159]
    ds_read_b64_tr_b16 v[68:69], v225 offset:32768
    v_mfma_f32_16x16x32_bf16 v[52:55], v[180:183], v[92:95], v[52:55]
    ds_read_b64_tr_b16 v[70:71], v225 offset:34816
    v_mfma_f32_16x16x32_bf16 v[160:163], v[184:187], v[88:91], v[160:163]
    ds_read_b64_tr_b16 v[72:73], v226 offset:32768
    buffer_load_dwordx4 v[120:123], v248, s[20:23], s64 offen sc1
    buffer_load_dwordx4 v[124:127], v249, s[20:23], s64 offen sc1
    v_mfma_f32_16x16x32_bf16 v[56:59], v[184:187], v[92:95], v[56:59]
    ds_read_b64_tr_b16 v[74:75], v226 offset:34816
    v_mfma_f32_16x16x32_bf16 v[164:167], v[188:191], v[88:91], v[164:167]
    ds_read_b64_tr_b16 v[76:77], v227 offset:32768
    s_add_u32 m0, s73, 81920
    s_nop 0
    buffer_load_dwordx4 v247, s[16:19], s46 offen lds
    s_add_u32 s46, s46, 8192
    s_add_u32 m0, s73, 82944
    s_nop 0
    buffer_load_dwordx4 v247, s[16:19], s46 offen lds
    v_mfma_f32_16x16x32_bf16 v[60:63], v[188:191], v[92:95], v[60:63]
    ds_read_b64_tr_b16 v[78:79], v227 offset:34816
    s_waitcnt lgkmcnt(8)
    s_waitcnt vmcnt(8)
    v_mfma_f32_16x16x32_bf16 v[152:155], v[192:195], v[96:99], v[152:155]
    ds_read_b64_tr_b16 v[176:177], v224 offset:49152
    v_mfma_f32_16x16x32_bf16 v[48:51], v[192:195], v[100:103], v[48:51]
    ds_read_b64_tr_b16 v[178:179], v224 offset:51200
    v_mfma_f32_16x16x32_bf16 v[156:159], v[196:199], v[96:99], v[156:159]
    ds_read_b64_tr_b16 v[180:181], v225 offset:49152
    v_mfma_f32_16x16x32_bf16 v[52:55], v[196:199], v[100:103], v[52:55]
    ds_read_b64_tr_b16 v[182:183], v225 offset:51200
    v_mfma_f32_16x16x32_bf16 v[160:163], v[200:203], v[96:99], v[160:163]
    ds_read_b64_tr_b16 v[184:185], v226 offset:49152
    buffer_load_dwordx4 v[128:131], v248, s[20:23], s65 offen sc1
    buffer_load_dwordx4 v[132:135], v249, s[20:23], s65 offen sc1
    v_mfma_f32_16x16x32_bf16 v[56:59], v[200:203], v[100:103], v[56:59]
    ds_read_b64_tr_b16 v[186:187], v226 offset:51200
    v_mfma_f32_16x16x32_bf16 v[164:167], v[204:207], v[96:99], v[164:167]
    ds_read_b64_tr_b16 v[188:189], v227 offset:49152
    s_add_u32 m0, s73, 98304
    s_nop 0
    buffer_load_dwordx4 v247, s[16:19], s50 offen lds
    s_add_u32 s50, s50, 8192
    s_add_u32 m0, s73, 99328
    s_nop 0
    buffer_load_dwordx4 v247, s[16:19], s50 offen lds
    v_and_b32 v252, 7, v2
    v_lshlrev_b32 v252, 8, v252
    s_lshl_b32 s64, s4, 11
    s_add_u32 s64, s64, 12603392
    buffer_load_dword v251, v252, s[20:23], s64 offen sc1
    v_mfma_f32_16x16x32_bf16 v[60:63], v[204:207], v[100:103], v[60:63]
    ds_read_b64_tr_b16 v[190:191], v227 offset:51200
    s_waitcnt lgkmcnt(8)
    s_waitcnt vmcnt(11)
    v_mfma_f32_16x16x32_bf16 v[152:155], v[64:67], v[104:107], v[152:155]
    ds_read_b64_tr_b16 v[192:193], v228 offset:0
    v_mfma_f32_16x16x32_bf16 v[48:51], v[64:67], v[108:111], v[48:51]
    ds_read_b64_tr_b16 v[194:195], v228 offset:2048
    v_mfma_f32_16x16x32_bf16 v[156:159], v[68:71], v[104:107], v[156:159]
    ds_read_b64_tr_b16 v[196:197], v229 offset:0
    v_mfma_f32_16x16x32_bf16 v[52:55], v[68:71], v[108:111], v[52:55]
    ds_read_b64_tr_b16 v[198:199], v229 offset:2048
    v_mfma_f32_16x16x32_bf16 v[160:163], v[72:75], v[104:107], v[160:163]
    ds_read_b64_tr_b16 v[200:201], v230 offset:0
    buffer_load_dwordx4 v[136:139], v248, s[20:23], s66 offen sc1
    buffer_load_dwordx4 v[140:143], v249, s[20:23], s66 offen sc1
    v_mfma_f32_16x16x32_bf16 v[56:59], v[72:75], v[108:111], v[56:59]
    ds_read_b64_tr_b16 v[202:203], v230 offset:2048
    v_mfma_f32_16x16x32_bf16 v[164:167], v[76:79], v[104:107], v[164:167]
    ds_read_b64_tr_b16 v[204:205], v231 offset:0
    v_mfma_f32_16x16x32_bf16 v[60:63], v[76:79], v[108:111], v[60:63]
    ds_read_b64_tr_b16 v[206:207], v231 offset:2048
    s_waitcnt lgkmcnt(8)
    s_waitcnt vmcnt(11)
    v_mfma_f32_16x16x32_bf16 v[152:155], v[176:179], v[112:115], v[152:155]
    ds_read_b64_tr_b16 v[64:65], v224 offset:0
    v_mfma_f32_16x16x32_bf16 v[48:51], v[176:179], v[116:119], v[48:51]
    ds_read_b64_tr_b16 v[66:67], v224 offset:2048
    v_mfma_f32_16x16x32_bf16 v[156:159], v[180:183], v[112:115], v[156:159]
    ds_read_b64_tr_b16 v[68:69], v225 offset:0
    v_mfma_f32_16x16x32_bf16 v[52:55], v[180:183], v[116:119], v[52:55]
    ds_read_b64_tr_b16 v[70:71], v225 offset:2048
    v_mfma_f32_16x16x32_bf16 v[160:163], v[184:187], v[112:115], v[160:163]
    ds_read_b64_tr_b16 v[72:73], v226 offset:0
    buffer_load_dwordx4 v[144:147], v248, s[20:23], s67 offen sc1
    buffer_load_dwordx4 v[148:151], v249, s[20:23], s67 offen sc1
    v_mfma_f32_16x16x32_bf16 v[56:59], v[184:187], v[116:119], v[56:59]
    ds_read_b64_tr_b16 v[74:75], v226 offset:2048
    v_mfma_f32_16x16x32_bf16 v[164:167], v[188:191], v[112:115], v[164:167]
    ds_read_b64_tr_b16 v[76:77], v227 offset:0
    v_mfma_f32_16x16x32_bf16 v[60:63], v[188:191], v[116:119], v[60:63]
    ds_read_b64_tr_b16 v[78:79], v227 offset:2048
    s_waitcnt lgkmcnt(8)
    s_cmp_lg_u32 s3, 7
    s_nop 4
    s_cbranch_scc1 L_wd_ok
    s_waitcnt vmcnt(4)
    v_cmp_gt_u32 vcc, 32, v251
    s_nop 4
    s_cbranch_vccz L_wd_ok
L_wd:
    s_sleep 1
    buffer_load_dword v251, v252, s[20:23], s64 offen sc1
    s_waitcnt vmcnt(0)
    v_cmp_gt_u32 vcc, 32, v251
    s_nop 4
    s_cbranch_vccnz L_wd
L_wd_ok:
    s_waitcnt vmcnt(5)
    s_barrier
    v_mfma_f32_16x16x32_bf16 v[152:155], v[192:195], v[120:123], v[152:155]
    ds_read_b64_tr_b16 v[176:177], v228 offset:16384
    v_mfma_f32_16x16x32_bf16 v[48:51], v[192:195], v[124:127], v[48:51]
    ds_read_b64_tr_b16 v[178:179], v228 offset:18432
    s_lshl_b32 s53, s3, 10
    s_add_u32 s52, s74, s53
    s_add_u32 m0, s53, 114688
    s_nop 0
    buffer_load_dwordx4 v5, s[20:23], s52 offen sc1 lds
    v_mfma_f32_16x16x32_bf16 v[156:159], v[196:199], v[120:123], v[156:159]
    ds_read_b64_tr_b16 v[180:181], v229 offset:16384
    v_mfma_f32_16x16x32_bf16 v[52:55], v[196:199], v[124:127], v[52:55]
    ds_read_b64_tr_b16 v[182:183], v229 offset:18432
    v_mfma_f32_16x16x32_bf16 v[160:163], v[200:203], v[120:123], v[160:163]
    ds_read_b64_tr_b16 v[184:185], v230 offset:16384
    s_add_u32 s52, s52, 8192
    s_add_u32 m0, s53, 122880
    s_nop 0
    buffer_load_dwordx4 v5, s[20:23], s52 offen sc1 lds
    v_mfma_f32_16x16x32_bf16 v[56:59], v[200:203], v[124:127], v[56:59]
    ds_read_b64_tr_b16 v[186:187], v230 offset:18432
    v_mfma_f32_16x16x32_bf16 v[164:167], v[204:207], v[120:123], v[164:167]
    ds_read_b64_tr_b16 v[188:189], v231 offset:16384
    s_add_u32 s52, s52, 8192
    s_add_u32 m0, s53, 131072
    s_nop 0
    buffer_load_dwordx4 v5, s[20:23], s52 offen sc1 lds
    v_mfma_f32_16x16x32_bf16 v[60:63], v[204:207], v[124:127], v[60:63]
    ds_read_b64_tr_b16 v[190:191], v231 offset:18432
    s_nop 6
L_ffn2:
    s_waitcnt lgkmcnt(8)
    v_mfma_f32_16x16x32_bf16 v[152:155], v[64:67], v[128:131], v[152:155]
    ds_read_b64_tr_b16 v[192:193], v228 offset:32768
    v_and_b32 v10, 1, v3
    v_lshlrev_b32 v10, 15, v10
    v_xor_b32 v10, 46649, v10
    v_cmp_eq_u32 vcc, 0, v4
    v_mfma_f32_16x16x32_bf16 v[48:51], v[64:67], v[132:135], v[48:51]
    ds_read_b64_tr_b16 v[194:195], v228 offset:34816
    v_cndmask_b32 v10, 0, v10, vcc
    s_sub_u32 s40, s71, 1
    s_sub_u32 s41, 0, s71
    v_and_b32 v98, s40, v10
    s_add_u32 s52, s52, 8192
    s_add_u32 m0, s53, 139264
    s_nop 0
    buffer_load_dwordx4 v5, s[20:23], s52 offen sc1 lds
    v_mfma_f32_16x16x32_bf16 v[156:159], v[68:71], v[128:131], v[156:159]
    ds_read_b64_tr_b16 v[196:197], v229 offset:32768
    v_and_b32 v100, s41, v10
    v_xor_b32 v96, 0x8000, v100
    v_mov_b32 v97, 0
    v_mov_b32 v99, 0
    v_mfma_f32_16x16x32_bf16 v[52:55], v[68:71], v[132:135], v[52:55]
    ds_read_b64_tr_b16 v[198:199], v229 offset:34816
    v_mov_b32 v101, 0
    s_lshl_b32 s40, s3, 13
    s_add_u32 s40, s40, 0
    v_add_u32 v11, s40, v5
    v_mfma_f32_16x16x32_bf16 v[160:163], v[72:75], v[128:131], v[160:163]
    ds_read_b64_tr_b16 v[200:201], v230 offset:32768
    v_xor_b32 v10, 32768, v11
    v_xor_b32 v12, 8192, v11
    v_xor_b32 v14, 40960, v11
    s_mul_i32 s41, s71, 7168
    s_add_u32 s52, s52, 8192
    s_add_u32 m0, s53, 16384
    s_nop 0
    buffer_load_dwordx4 v5, s[20:23], s52 offen sc1 lds
    v_mfma_f32_16x16x32_bf16 v[56:59], v[72:75], v[132:135], v[56:59]
    ds_read_b64_tr_b16 v[202:203], v230 offset:34816
    s_sub_u32 s40, s40, s41
    v_add_u32 v13, s40, v5
    s_mov_b32 s54, 0xbf317218
    v_permlane16_swap_b32 v232, v234
    v_mfma_f32_16x16x32_bf16 v[164:167], v[76:79], v[128:131], v[164:167]
    ds_read_b64_tr_b16 v[204:205], v231 offset:32768
    v_permlane16_swap_b32 v233, v235
    s_add_u32 s52, s52, 8192
    s_add_u32 m0, s53, 24576
    s_nop 0
    buffer_load_dwordx4 v5, s[20:23], s52 offen sc1 lds
    v_mfma_f32_16x16x32_bf16 v[60:63], v[76:79], v[132:135], v[60:63]
    ds_read_b64_tr_b16 v[206:207], v231 offset:34816
    s_waitcnt lgkmcnt(8)
    s_waitcnt vmcnt(8)
    v_mfma_f32_16x16x32_bf16 v[152:155], v[176:179], v[136:139], v[152:155]
    v_xor_b32 v64, 0x80008000, v18
    v_xor_b32 v65, 0x80008000, v19
    v_mfma_f32_16x16x32_bf16 v[48:51], v[176:179], v[140:143], v[48:51]
    v_mov_b64 v[66:67], v[16:17]
    v_xor_b32 v68, 0x80008000, v22
    s_add_u32 s52, s52, 8192
    s_add_u32 m0, s53, 32768
    s_nop 0
    buffer_load_dwordx4 v5, s[20:23], s52 offen sc1 lds
    v_mfma_f32_16x16x32_bf16 v[156:159], v[180:183], v[136:139], v[156:159]
    v_xor_b32 v69, 0x80008000, v23
    v_mov_b64 v[70:71], v[20:21]
    v_mfma_f32_16x16x32_bf16 v[52:55], v[180:183], v[140:143], v[52:55]
    v_xor_b32 v72, 0x80008000, v26
    v_xor_b32 v73, 0x80008000, v27
    v_mfma_f32_16x16x32_bf16 v[160:163], v[184:187], v[136:139], v[160:163]
    v_mov_b64 v[74:75], v[24:25]
    v_xor_b32 v76, 0x80008000, v30
    s_add_u32 s52, s52, 8192
    s_add_u32 m0, s53, 40960
    s_nop 0
    buffer_load_dwordx4 v5, s[20:23], s52 offen sc1 lds
    v_mfma_f32_16x16x32_bf16 v[56:59], v[184:187], v[140:143], v[56:59]
    v_xor_b32 v77, 0x80008000, v31
    v_mov_b64 v[78:79], v[28:29]
    v_mfma_f32_16x16x32_bf16 v[164:167], v[188:191], v[136:139], v[164:167]
    s_lshl_b32 s53, s6, 10
    s_add_u32 s52, s74, s53
    s_add_u32 s52, s52, 65536
    s_add_u32 m0, s53, 151552
    s_nop 0
    buffer_load_dwordx4 v5, s[20:23], s52 offen sc1 lds
    v_mfma_f32_16x16x32_bf16 v[60:63], v[188:191], v[140:143], v[60:63]
    s_waitcnt lgkmcnt(0)
    s_waitcnt vmcnt(9)
    v_mfma_f32_16x16x32_bf16 v[152:155], v[192:195], v[144:147], v[152:155]
    v_xor_b32 v80, 0x80008000, v34
    v_xor_b32 v81, 0x80008000, v35
    v_mfma_f32_16x16x32_bf16 v[48:51], v[192:195], v[148:151], v[48:51]
    v_mov_b64 v[82:83], v[32:33]
    v_xor_b32 v84, 0x80008000, v38
    v_mfma_f32_16x16x32_bf16 v[156:159], v[196:199], v[144:147], v[156:159]
    v_xor_b32 v85, 0x80008000, v39
    v_mov_b64 v[86:87], v[36:37]
    v_mfma_f32_16x16x32_bf16 v[52:55], v[196:199], v[148:151], v[52:55]
    v_xor_b32 v88, 0x80008000, v42
    v_xor_b32 v89, 0x80008000, v43
    v_mfma_f32_16x16x32_bf16 v[160:163], v[200:203], v[144:147], v[160:163]
    v_mov_b64 v[90:91], v[40:41]
    v_xor_b32 v92, 0x80008000, v46
    v_mfma_f32_16x16x32_bf16 v[56:59], v[200:203], v[148:151], v[56:59]
    v_xor_b32 v93, 0x80008000, v47
    v_mov_b64 v[94:95], v[44:45]
    v_mfma_f32_16x16x32_bf16 v[164:167], v[204:207], v[144:147], v[164:167]
    v_mfma_f32_16x16x32_bf16 v[60:63], v[204:207], v[148:151], v[60:63]
    s_waitcnt vmcnt(5)
    s_barrier
    ds_read_b128 v[104:107], v236 offset:0
    ds_read_b128 v[108:111], v236 offset:1024
    ds_read_b128 v[112:115], v236 offset:8192
    ds_read_b128 v[116:119], v236 offset:9216
    ds_read_b128 v[120:123], v236 offset:16384
    ds_read_b128 v[124:127], v236 offset:17408
    ds_read_b128 v[192:195], v236 offset:24576
    ds_read_b128 v[196:199], v236 offset:25600
    s_waitcnt lgkmcnt(7)
    v_mfma_f32_16x16x32_bf16 v[128:131], v[104:107], v[16:19], 0
    v_lshlrev_b32 v168, 16, v232
    v_mfma_f32_16x16x32_bf16 v[132:135], v[104:107], v[64:67], 0
    v_and_b32 v169, 0xffff0000, v232
    v_lshlrev_b32 v170, 16, v233
    s_waitcnt lgkmcnt(6)
    v_mfma_f32_16x16x32_bf16 v[136:139], v[108:111], v[16:19], 0
    v_and_b32 v171, 0xffff0000, v233
    v_mfma_f32_16x16x32_bf16 v[140:143], v[108:111], v[64:67], 0
    v_lshlrev_b32 v172, 16, v234
    v_and_b32 v173, 0xffff0000, v234
    s_waitcnt lgkmcnt(5)
    v_mfma_f32_16x16x32_bf16 v[128:131], v[112:115], v[20:23], v[128:131]
    v_lshlrev_b32 v174, 16, v235
    v_mfma_f32_16x16x32_bf16 v[132:135], v[112:115], v[68:71], v[132:135]
    v_and_b32 v175, 0xffff0000, v235
    v_fma_f32 v152, v152, s54, v168
    s_waitcnt lgkmcnt(4)
    v_mfma_f32_16x16x32_bf16 v[136:139], v[116:119], v[20:23], v[136:139]
    v_fma_f32 v153, v153, s54, v169
    v_mfma_f32_16x16x32_bf16 v[140:143], v[116:119], v[68:71], v[140:143]
    v_fma_f32 v154, v154, s54, v170
    v_fma_f32 v155, v155, s54, v171
    s_waitcnt lgkmcnt(3)
    v_mfma_f32_16x16x32_bf16 v[128:131], v[120:123], v[24:27], v[128:131]
    v_fma_f32 v156, v156, s54, v172
    v_mfma_f32_16x16x32_bf16 v[132:135], v[120:123], v[72:75], v[132:135]
    v_fma_f32 v157, v157, s54, v173
    ds_write_b128 v10, v[160:163] offset:49152
    v_fma_f32 v158, v158, s54, v174
    s_waitcnt vmcnt(0)
    s_barrier
    ds_read_b128 v[200:203], v238 offset:0
    ds_read_b128 v[204:207], v238 offset:1024
    ds_read_b128 v[176:179], v238 offset:8192
    ds_read_b128 v[180:183], v238 offset:9216
    ds_read_b128 v[184:187], v238 offset:16384
    s_waitcnt lgkmcnt(8)
    v_mfma_f32_16x16x32_bf16 v[136:139], v[124:127], v[24:27], v[136:139]
    ds_read_b128 v[188:191], v238 offset:17408
    v_mfma_f32_16x16x32_bf16 v[140:143], v[124:127], v[72:75], v[140:143]
    v_fma_f32 v159, v159, s54, v175
    s_waitcnt lgkmcnt(8)
    v_mfma_f32_16x16x32_bf16 v[128:131], v[192:195], v[28:31], v[128:131]
    ds_read_b128 v[104:107], v238 offset:24576
    v_mfma_f32_16x16x32_bf16 v[132:135], v[192:195], v[76:79], v[132:135]
    ds_write_b128 v10, v[164:167] offset:50176
    s_waitcnt lgkmcnt(9)
    v_mfma_f32_16x16x32_bf16 v[136:139], v[196:199], v[28:31], v[136:139]
    ds_read_b128 v[108:111], v238 offset:25600
    v_mfma_f32_16x16x32_bf16 v[140:143], v[196:199], v[76:79], v[140:143]
    s_waitcnt lgkmcnt(8)
    v_mfma_f32_16x16x32_bf16 v[128:131], v[200:203], v[32:35], v[128:131]
    ds_read_b128 v[112:115], v237 offset:0
    v_mfma_f32_16x16x32_bf16 v[132:135], v[200:203], v[80:83], v[132:135]
    ds_write_b128 v12, v[48:51] offset:51200
    s_waitcnt lgkmcnt(9)
    v_mfma_f32_16x16x32_bf16 v[136:139], v[204:207], v[32:35], v[136:139]
    ds_read_b128 v[116:119], v237 offset:1024
    v_mfma_f32_16x16x32_bf16 v[140:143], v[204:207], v[80:83], v[140:143]
    s_waitcnt lgkmcnt(9)
    v_mfma_f32_16x16x32_bf16 v[128:131], v[176:179], v[36:39], v[128:131]
    v_mfma_f32_16x16x32_bf16 v[132:135], v[176:179], v[84:87], v[132:135]
    ds_write_b128 v12, v[52:55] offset:52224
    s_waitcnt lgkmcnt(9)
    v_mfma_f32_16x16x32_bf16 v[136:139], v[180:183], v[36:39], v[136:139]
    v_mfma_f32_16x16x32_bf16 v[140:143], v[180:183], v[84:87], v[140:143]
    ds_write_b128 v14, v[56:59] offset:53248
    s_waitcnt lgkmcnt(9)
    v_mfma_f32_16x16x32_bf16 v[128:131], v[184:187], v[40:43], v[128:131]
    v_mfma_f32_16x16x32_bf16 v[132:135], v[184:187], v[88:91], v[132:135]
    ds_write_b128 v14, v[60:63] offset:54272
    s_waitcnt lgkmcnt(9)
    v_mfma_f32_16x16x32_bf16 v[136:139], v[188:191], v[40:43], v[136:139]
    v_mfma_f32_16x16x32_bf16 v[140:143], v[188:191], v[88:91], v[140:143]
    s_waitcnt lgkmcnt(0)
    s_barrier
    ds_read_b128 v[176:179], v11 offset:49152
    ds_read_b128 v[180:183], v11 offset:50176
    ds_read_b128 v[184:187], v11 offset:51200
    ds_read_b128 v[188:191], v11 offset:52224
    ds_read_b128 v[192:195], v11 offset:53248
    ds_read_b128 v[196:199], v11 offset:54272
    v_mfma_f32_16x16x32_bf16 v[128:131], v[104:107], v[44:47], v[128:131]
    v_mfma_f32_16x16x32_bf16 v[132:135], v[104:107], v[92:95], v[132:135]
    v_mfma_f32_16x16x32_bf16 v[136:139], v[108:111], v[44:47], v[136:139]
    v_mfma_f32_16x16x32_bf16 v[140:143], v[108:111], v[92:95], v[140:143]
    v_mfma_f32_16x16x32_bf16 v[128:131], v[112:115], v[98:101], v[128:131]
    v_mfma_f32_16x16x32_bf16 v[132:135], v[112:115], v[96:99], v[132:135]
    v_mfma_f32_16x16x32_bf16 v[136:139], v[116:119], v[98:101], v[136:139]
    v_mfma_f32_16x16x32_bf16 v[140:143], v[116:119], v[96:99], v[140:143]
    s_waitcnt lgkmcnt(5)
    v_fma_f32 v152, v176, s54, v152
    v_fma_f32 v153, v177, s54, v153
    v_fma_f32 v154, v178, s54, v154
    v_fma_f32 v155, v179, s54, v155
    s_waitcnt lgkmcnt(4)
    v_fma_f32 v156, v180, s54, v156
    v_fma_f32 v157, v181, s54, v157
    v_fma_f32 v158, v182, s54, v158
    v_fma_f32 v159, v183, s54, v159
    s_waitcnt lgkmcnt(3)
    v_fma_f32 v152, v184, s54, v152
    v_fma_f32 v153, v185, s54, v153
    v_fma_f32 v154, v186, s54, v154
    v_fma_f32 v155, v187, s54, v155
    s_waitcnt lgkmcnt(2)
    v_fma_f32 v156, v188, s54, v156
    v_fma_f32 v157, v189, s54, v157
    v_fma_f32 v158, v190, s54, v158
    v_fma_f32 v159, v191, s54, v159
    s_waitcnt lgkmcnt(1)
    v_fma_f32 v152, v192, s54, v152
    v_fma_f32 v153, v193, s54, v153
    v_fma_f32 v154, v194, s54, v154
    v_fma_f32 v155, v195, s54, v155
    s_waitcnt lgkmcnt(0)
    v_fma_f32 v156, v196, s54, v156
    v_fma_f32 v157, v197, s54, v157
    v_fma_f32 v158, v198, s54, v158
    v_fma_f32 v159, v199, s54, v159
    v_cvt_pk_bf16_f32 v104, v128, v129
    v_cvt_pk_bf16_f32 v105, v130, v131
    v_cvt_pk_bf16_f32 v106, v136, v137
    v_cvt_pk_bf16_f32 v107, v138, v139
    v_cvt_pk_bf16_f32 v108, v132, v133
    v_cvt_pk_bf16_f32 v109, v134, v135
    v_cvt_pk_bf16_f32 v110, v140, v141
    v_cvt_pk_bf16_f32 v111, v142, v143
    v_mfma_f32_16x16x32_bf16 v[144:147], v[104:107], v[208:211], 0
    v_mfma_f32_16x16x32_bf16 v[148:151], v[104:107], v[216:219], 0
    v_mfma_f32_16x16x32_bf16 v[144:147], v[108:111], v[212:215], v[144:147]
    v_mfma_f32_16x16x32_bf16 v[148:151], v[108:111], v[220:223], v[148:151]
    s_nop 6
    ds_write_b128 v13, v[144:147] offset:55296
    ds_write_b128 v13, v[148:151] offset:63488
    s_waitcnt lgkmcnt(0)
    s_barrier
    ds_read_b128 v[72:75], v11 offset:55296
    ds_read_b128 v[76:79], v11 offset:56320
    s_waitcnt lgkmcnt(1)
    v_fma_f32 v152, v72, s54, v152
    v_fma_f32 v154, v73, s54, v154
    v_fma_f32 v156, v74, s54, v156
    v_fma_f32 v158, v75, s54, v158
    s_waitcnt lgkmcnt(0)
    v_fma_f32 v153, v76, s54, v153
    v_fma_f32 v155, v77, s54, v155
    v_fma_f32 v157, v78, s54, v157
    v_fma_f32 v159, v79, s54, v159
    v_cvt_pk_bf16_f32 v80, v152, v153
    v_cvt_pk_bf16_f32 v81, v154, v155
    v_cvt_pk_bf16_f32 v82, v156, v157
    v_cvt_pk_bf16_f32 v83, v158, v159
    s_nop 0
    v_permlane16_swap_b32 v80, v82
    v_permlane16_swap_b32 v81, v83
    buffer_store_dwordx4 v[80:83], v253, s[24:27], 0 offen sc1
    s_endpgm
    s_nop 0
L_x:
    s_endpgm
L_codeend:
.section .rodata,"a"
.p2align 6
.amdhsa_kernel parallel_sum__spectral_gfnet__dense_activation_silu__prompt_kernel
  .amdhsa_next_free_vgpr 256
  .amdhsa_next_free_sgpr 102
  .amdhsa_accum_offset 256
  .amdhsa_group_segment_fixed_size 0
  .amdhsa_kernarg_size 72
  .amdhsa_user_sgpr_count 2
  .amdhsa_user_sgpr_kernarg_segment_ptr 1
  .amdhsa_system_sgpr_workgroup_id_x 1
.end_amdhsa_kernel
```
